```python
import torch

def _softmax(x, axis=-1):
    return torch.softmax(x, dim=axis)
def _gelu(x):
    return torch.nn.functional.gelu(x, approximate="tanh")
def _silu(x):
    return torch.nn.functional.silu(x)
def _sigmoid(x):
    return torch.sigmoid(x)
def _layernorm(x, axis=-1, eps=1e-5):
    m = x.mean(dim=axis, keepdim=True)
    v = x.var(dim=axis, keepdim=True, unbiased=False)
    return (x - m) / torch.sqrt(v + eps)
def _scatter_add(tgt, idx, src, axis=0):
    return tgt.clone().index_add_(axis, idx, src)
def _segment_sum(src, seg, n):
    out = torch.zeros((n,) + src.shape[1:], dtype=src.dtype)
    return out.index_add_(0, seg, src)
def _pad(x, pw):
    flat = tuple(v for pair in reversed(pw) for v in pair)
    return torch.nn.functional.pad(x, flat)

kernel_name = 'parallel_sum__mha_block_cached__mixer_channel_mlp__decode'

def setup_inputs():

    _w = (lambda a: (lambda t: t.to(torch.bfloat16) if t.is_floating_point() else t)(torch.as_tensor(a)))
    def _A_setup():
        B, Sq, D = 8, 1, 576
        H, Sk, Dh = 32, 4096, 128
        return {
            "x": _w((lambda *s: torch.randn(*s, dtype=torch.bfloat16) * 0.05)(B, Sq, D)),
            "k_cache": _w((lambda *s: torch.randn(*s, dtype=torch.bfloat16) * 3.2)(B, H, Sk, Dh)),
            "v_cache": _w((lambda *s: torch.randn(*s, dtype=torch.bfloat16) * 0.4)(B, H, Sk, Dh)),
            "wq": _w((lambda *s: torch.randn(*s, dtype=torch.bfloat16) * 3.2)(D, H * Dh) * (D ** -0.5)),
            "wo": _w((lambda *s: torch.randn(*s, dtype=torch.bfloat16) * 0.4)(H * Dh, D) * ((H * Dh) ** -0.5)),
        }
    _A_in = _A_setup()

    def _B_setup():
        B, S, D, F = 8, 1, 576, 4608
        return {
            "x": _w((lambda *s: torch.randn(*s, dtype=torch.bfloat16) * 0.05)(B, S, D)),
            "w1": _w((lambda *s: torch.randn(*s, dtype=torch.bfloat16) * 3.2)(D, F) * (D ** -0.5)),
            "b1": _w((lambda *s: torch.randn(*s, dtype=torch.bfloat16) * 1.6)(F)),
            "w2": _w((lambda *s: torch.randn(*s, dtype=torch.bfloat16) * 0.1)(F, D) * (F ** -0.5)),
            "b2": _w((lambda *s: torch.randn(*s, dtype=torch.bfloat16) * 0.1)(D)),
        }
    _B_in = _B_setup()

    return {
        "A_x": _A_in["x"],
        "A_k_cache": _A_in["k_cache"],
        "A_v_cache": _A_in["v_cache"],
        "A_wq": _A_in["wq"],
        "A_wo": _A_in["wo"],
        "B_x": _B_in["x"],
        "B_w1": _B_in["w1"],
        "B_b1": _B_in["b1"],
        "B_w2": _B_in["w2"],
        "B_b2": _B_in["b2"],
    }

def reference(A_x, A_k_cache, A_v_cache, A_wq, A_wo, B_x, B_w1, B_b1, B_w2, B_b2):
    def _A_ref(x, k_cache, v_cache, wq, wo):
        B, Sq, D = x.shape
        H, Dh = 32, 128
        q = (lambda x, *d: x.permute(*d))((x @ wq).reshape(B, Sq, H, Dh), 0, 2, 1, 3)
        scores = torch.einsum("bhqd,bhkd->bhqk", q, k_cache) * (Dh ** -0.5)
        p = _softmax(scores, axis=-1)
        o = torch.einsum("bhqk,bhkd->bhqd", p, v_cache)
        return (lambda x, *d: x.permute(*d))(o, 0, 2, 1, 3).reshape(B, Sq, H * Dh) @ wo

    def _B_ref(x, w1, b1, w2, b2):
        y = _layernorm(x, axis=-1)
        h = _gelu(torch.einsum("bsd,df->bsf", y, w1) + b1)
        return torch.einsum("bsf,fd->bsd", h, w2) + b2

    x = A_x
    xn = _layernorm(x, axis=-1)
    return x + _A_ref(xn, A_k_cache, A_v_cache, A_wq, A_wo) + _B_ref(xn, B_w1, B_b1, B_w2, B_b2)
```

```asm
; @launch grid=(256,1,1) block=(512,1,1) lds=154624
.amdgcn_target "amdgcn-amd-amdhsa--gfx950"
.text
.globl parallel_sum__mha_block_cached__mixer_channel_mlp__decode_kernel
.p2align 8
.type parallel_sum__mha_block_cached__mixer_channel_mlp__decode_kernel,@function
parallel_sum__mha_block_cached__mixer_channel_mlp__decode_kernel:
  s_cmp_ge_u32 s2, 256
  s_cbranch_scc1 L_end
  s_load_dwordx16 s[4:19], s[0:1], 0
  s_load_dwordx8 s[20:27], s[0:1], 64
  s_load_dwordx2 s[28:29], s[0:1], 96
  v_lshrrev_b32 v2, 6, v0
  v_and_b32 v1, 63, v0
  v_readfirstlane_b32 s30, v2
  s_lshr_b32 s31, s2, 5
  s_and_b32 s45, s2, 31
  s_mov_b32 s39, s45
  s_mov_b32 s38, 0xffff0000
  s_mov_b32 s63, 0x3fb8aa3b
  s_cmp_ge_u32 s30, 4
  s_cbranch_scc1 L_weights
  v_lshlrev_b32 v2, 4, v1
  s_mul_i32 s50, s30, 4096
  v_add_u32 v2, s50, v2
  s_lshl_b32 s50, s31, 5
  s_add_u32 s50, s50, s39
  s_lshl_b32 s50, s50, 20
  s_mov_b32 s36, 0
  s_lshl_b32 s51, s30, 15
  s_add_u32 s51, s51, 23552
  s_waitcnt lgkmcnt(0)
  s_add_u32 s32, s6, s50
  s_addc_u32 s33, s7, 0
  s_and_b32 s33, s33, 0xffff
  s_mov_b32 s34, 1048576
  s_mov_b32 s35, 0x20000
  s_add_u32 s60, s8, s50
  s_addc_u32 s61, s9, 0
  s_and_b32 s61, s61, 0xffff
  buffer_load_dwordx4 v[64:67], v2, s[32:35], s36 offen nt
  buffer_load_dwordx4 v[68:71], v2, s[32:35], s36 offen offset:1024 nt
  buffer_load_dwordx4 v[72:75], v2, s[32:35], s36 offen offset:2048 nt
  buffer_load_dwordx4 v[76:79], v2, s[32:35], s36 offen offset:3072 nt
  s_addk_i32 s36, 16384
  buffer_load_dwordx4 v[80:83], v2, s[32:35], s36 offen nt
  s_barrier
  s_waitcnt vmcnt(4)
  buffer_load_dwordx4 v[84:87], v2, s[32:35], s36 offen offset:1024 nt
  s_waitcnt vmcnt(4)
  buffer_load_dwordx4 v[88:91], v2, s[32:35], s36 offen offset:2048 nt
  s_waitcnt vmcnt(4)
  buffer_load_dwordx4 v[92:95], v2, s[32:35], s36 offen offset:3072 nt
  s_addk_i32 s36, 16384
  s_waitcnt vmcnt(4)
  buffer_load_dwordx4 v[96:99], v2, s[32:35], s36 offen nt
  s_waitcnt vmcnt(4)
  buffer_load_dwordx4 v[100:103], v2, s[32:35], s36 offen offset:1024 nt
  s_waitcnt vmcnt(4)
  buffer_load_dwordx4 v[104:107], v2, s[32:35], s36 offen offset:2048 nt
  s_waitcnt vmcnt(4)
  buffer_load_dwordx4 v[108:111], v2, s[32:35], s36 offen offset:3072 nt
  s_addk_i32 s36, 16384
  s_waitcnt vmcnt(4)
  buffer_load_dwordx4 v[112:115], v2, s[32:35], s36 offen nt
  s_waitcnt vmcnt(4)
  buffer_load_dwordx4 v[116:119], v2, s[32:35], s36 offen offset:1024 nt
  s_waitcnt vmcnt(4)
  buffer_load_dwordx4 v[120:123], v2, s[32:35], s36 offen offset:2048 nt
  s_waitcnt vmcnt(4)
  buffer_load_dwordx4 v[124:127], v2, s[32:35], s36 offen offset:3072 nt
  s_addk_i32 s36, 16384
  s_waitcnt vmcnt(4)
  s_add_u32 m0, s51, 0
  s_add_u32 s52, s36, 0
  buffer_load_dwordx4 v2, s[32:35], s52 offen nt lds
  s_waitcnt vmcnt(4)
  s_add_u32 m0, s51, 1024
  s_add_u32 s52, s36, 1024
  buffer_load_dwordx4 v2, s[32:35], s52 offen nt lds
  s_waitcnt vmcnt(4)
  s_add_u32 m0, s51, 2048
  s_add_u32 s52, s36, 2048
  buffer_load_dwordx4 v2, s[32:35], s52 offen nt lds
  s_waitcnt vmcnt(4)
  s_add_u32 m0, s51, 3072
  s_add_u32 s52, s36, 3072
  buffer_load_dwordx4 v2, s[32:35], s52 offen nt lds
  s_addk_i32 s36, 16384
  s_waitcnt vmcnt(4)
  s_add_u32 m0, s51, 4096
  s_add_u32 s52, s36, 0
  buffer_load_dwordx4 v2, s[32:35], s52 offen nt lds
  s_waitcnt vmcnt(4)
  s_add_u32 m0, s51, 5120
  s_add_u32 s52, s36, 1024
  buffer_load_dwordx4 v2, s[32:35], s52 offen nt lds
  s_waitcnt vmcnt(4)
  s_add_u32 m0, s51, 6144
  s_add_u32 s52, s36, 2048
  buffer_load_dwordx4 v2, s[32:35], s52 offen nt lds
  s_waitcnt vmcnt(4)
  s_add_u32 m0, s51, 7168
  s_add_u32 s52, s36, 3072
  buffer_load_dwordx4 v2, s[32:35], s52 offen nt lds
  s_addk_i32 s36, 16384
  s_waitcnt vmcnt(4)
  s_add_u32 m0, s51, 8192
  s_add_u32 s52, s36, 0
  buffer_load_dwordx4 v2, s[32:35], s52 offen nt lds
  s_waitcnt vmcnt(4)
  s_add_u32 m0, s51, 9216
  s_add_u32 s52, s36, 1024
  buffer_load_dwordx4 v2, s[32:35], s52 offen nt lds
  s_waitcnt vmcnt(4)
  s_add_u32 m0, s51, 10240
  s_add_u32 s52, s36, 2048
  buffer_load_dwordx4 v2, s[32:35], s52 offen nt lds
  s_waitcnt vmcnt(4)
  s_add_u32 m0, s51, 11264
  s_add_u32 s52, s36, 3072
  buffer_load_dwordx4 v2, s[32:35], s52 offen nt lds
  s_addk_i32 s36, 16384
  s_waitcnt vmcnt(4)
  s_add_u32 m0, s51, 12288
  s_add_u32 s52, s36, 0
  buffer_load_dwordx4 v2, s[32:35], s52 offen nt lds
  s_waitcnt vmcnt(4)
  s_add_u32 m0, s51, 13312
  s_add_u32 s52, s36, 1024
  buffer_load_dwordx4 v2, s[32:35], s52 offen nt lds
  s_waitcnt vmcnt(4)
  s_add_u32 m0, s51, 14336
  s_add_u32 s52, s36, 2048
  buffer_load_dwordx4 v2, s[32:35], s52 offen nt lds
  s_waitcnt vmcnt(4)
  s_add_u32 m0, s51, 15360
  s_add_u32 s52, s36, 3072
  buffer_load_dwordx4 v2, s[32:35], s52 offen nt lds
  s_addk_i32 s36, 16384
  s_waitcnt vmcnt(4)
  s_add_u32 m0, s51, 16384
  s_add_u32 s52, s36, 0
  buffer_load_dwordx4 v2, s[32:35], s52 offen nt lds
  s_waitcnt vmcnt(4)
  s_add_u32 m0, s51, 17408
  s_add_u32 s52, s36, 1024
  buffer_load_dwordx4 v2, s[32:35], s52 offen nt lds
  s_waitcnt vmcnt(4)
  s_add_u32 m0, s51, 18432
  s_add_u32 s52, s36, 2048
  buffer_load_dwordx4 v2, s[32:35], s52 offen nt lds
  s_waitcnt vmcnt(4)
  s_add_u32 m0, s51, 19456
  s_add_u32 s52, s36, 3072
  buffer_load_dwordx4 v2, s[32:35], s52 offen nt lds
  s_addk_i32 s36, 16384
  s_waitcnt vmcnt(4)
  s_add_u32 m0, s51, 20480
  s_add_u32 s52, s36, 0
  buffer_load_dwordx4 v2, s[32:35], s52 offen nt lds
  s_waitcnt vmcnt(4)
  s_add_u32 m0, s51, 21504
  s_add_u32 s52, s36, 1024
  buffer_load_dwordx4 v2, s[32:35], s52 offen nt lds
  s_waitcnt vmcnt(4)
  s_add_u32 m0, s51, 22528
  s_add_u32 s52, s36, 2048
  buffer_load_dwordx4 v2, s[32:35], s52 offen nt lds
  s_waitcnt vmcnt(4)
  s_add_u32 m0, s51, 23552
  s_add_u32 s52, s36, 3072
  buffer_load_dwordx4 v2, s[32:35], s52 offen nt lds
  s_addk_i32 s36, 16384
  s_waitcnt vmcnt(4)
  s_add_u32 m0, s51, 24576
  s_add_u32 s52, s36, 0
  buffer_load_dwordx4 v2, s[32:35], s52 offen nt lds
  s_waitcnt vmcnt(4)
  s_add_u32 m0, s51, 25600
  s_add_u32 s52, s36, 1024
  buffer_load_dwordx4 v2, s[32:35], s52 offen nt lds
  s_waitcnt vmcnt(4)
  s_add_u32 m0, s51, 26624
  s_add_u32 s52, s36, 2048
  buffer_load_dwordx4 v2, s[32:35], s52 offen nt lds
  s_waitcnt vmcnt(4)
  s_add_u32 m0, s51, 27648
  s_add_u32 s52, s36, 3072
  buffer_load_dwordx4 v2, s[32:35], s52 offen nt lds
  s_addk_i32 s36, 16384
  s_waitcnt vmcnt(4)
  s_add_u32 m0, s51, 28672
  s_add_u32 s52, s36, 0
  buffer_load_dwordx4 v2, s[32:35], s52 offen nt lds
  s_waitcnt vmcnt(4)
  s_add_u32 m0, s51, 29696
  s_add_u32 s52, s36, 1024
  buffer_load_dwordx4 v2, s[32:35], s52 offen nt lds
  s_waitcnt vmcnt(4)
  s_add_u32 m0, s51, 30720
  s_add_u32 s52, s36, 2048
  buffer_load_dwordx4 v2, s[32:35], s52 offen nt lds
  s_waitcnt vmcnt(4)
  s_add_u32 m0, s51, 31744
  s_add_u32 s52, s36, 3072
  buffer_load_dwordx4 v2, s[32:35], s52 offen nt lds
  s_addk_i32 s36, 16384
  s_waitcnt vmcnt(4)
  buffer_load_dwordx4 v[128:131], v2, s[32:35], s36 offen nt
  s_waitcnt vmcnt(4)
  buffer_load_dwordx4 v[132:135], v2, s[32:35], s36 offen offset:1024 nt
  s_waitcnt vmcnt(4)
  buffer_load_dwordx4 v[136:139], v2, s[32:35], s36 offen offset:2048 nt
  s_waitcnt vmcnt(4)
  buffer_load_dwordx4 v[140:143], v2, s[32:35], s36 offen offset:3072 nt
  s_addk_i32 s36, 16384
  s_waitcnt vmcnt(4)
  buffer_load_dwordx4 v[144:147], v2, s[32:35], s36 offen nt
  s_waitcnt vmcnt(4)
  buffer_load_dwordx4 v[148:151], v2, s[32:35], s36 offen offset:1024 nt
  s_waitcnt vmcnt(4)
  buffer_load_dwordx4 v[152:155], v2, s[32:35], s36 offen offset:2048 nt
  s_waitcnt vmcnt(4)
  buffer_load_dwordx4 v[156:159], v2, s[32:35], s36 offen offset:3072 nt
  s_addk_i32 s36, 16384
  s_waitcnt vmcnt(4)
  buffer_load_dwordx4 v[160:163], v2, s[32:35], s36 offen nt
  s_waitcnt vmcnt(4)
  buffer_load_dwordx4 v[164:167], v2, s[32:35], s36 offen offset:1024 nt
  s_waitcnt vmcnt(4)
  buffer_load_dwordx4 v[168:171], v2, s[32:35], s36 offen offset:2048 nt
  s_waitcnt vmcnt(4)
  buffer_load_dwordx4 v[172:175], v2, s[32:35], s36 offen offset:3072 nt
  s_addk_i32 s36, 16384
  s_waitcnt vmcnt(4)
  buffer_load_dwordx4 v[176:179], v2, s[32:35], s36 offen nt
  s_waitcnt vmcnt(4)
  buffer_load_dwordx4 v[180:183], v2, s[32:35], s36 offen offset:1024 nt
  s_waitcnt vmcnt(4)
  buffer_load_dwordx4 v[184:187], v2, s[32:35], s36 offen offset:2048 nt
  s_waitcnt vmcnt(4)
  buffer_load_dwordx4 v[188:191], v2, s[32:35], s36 offen offset:3072 nt
  s_addk_i32 s36, 16384
  s_waitcnt vmcnt(4)
  buffer_load_dwordx4 v[192:195], v2, s[32:35], s36 offen nt
  s_waitcnt vmcnt(4)
  buffer_load_dwordx4 v[196:199], v2, s[32:35], s36 offen offset:1024 nt
  s_waitcnt vmcnt(4)
  buffer_load_dwordx4 v[200:203], v2, s[32:35], s36 offen offset:2048 nt
  s_waitcnt vmcnt(4)
  buffer_load_dwordx4 v[204:207], v2, s[32:35], s36 offen offset:3072 nt
  s_addk_i32 s36, 16384
  s_waitcnt vmcnt(4)
  buffer_load_dwordx4 v[208:211], v2, s[32:35], s36 offen nt
  s_waitcnt vmcnt(4)
  buffer_load_dwordx4 v[212:215], v2, s[32:35], s36 offen offset:1024 nt
  s_waitcnt vmcnt(4)
  buffer_load_dwordx4 v[216:219], v2, s[32:35], s36 offen offset:2048 nt
  s_waitcnt vmcnt(4)
  buffer_load_dwordx4 v[220:223], v2, s[32:35], s36 offen offset:3072 nt
  s_addk_i32 s36, 16384
  s_waitcnt vmcnt(4)
  buffer_load_dwordx4 v[224:227], v2, s[32:35], s36 offen nt
  s_waitcnt vmcnt(4)
  buffer_load_dwordx4 v[228:231], v2, s[32:35], s36 offen offset:1024 nt
  s_waitcnt vmcnt(4)
  buffer_load_dwordx4 v[232:235], v2, s[32:35], s36 offen offset:2048 nt
  s_waitcnt vmcnt(4)
  buffer_load_dwordx4 v[236:239], v2, s[32:35], s36 offen offset:3072 nt
  s_addk_i32 s36, 16384
  s_waitcnt vmcnt(4)
  buffer_load_dwordx4 v[240:243], v2, s[32:35], s36 offen nt
  s_waitcnt vmcnt(4)
  buffer_load_dwordx4 v[244:247], v2, s[32:35], s36 offen offset:1024 nt
  s_waitcnt vmcnt(4)
  buffer_load_dwordx4 v[248:251], v2, s[32:35], s36 offen offset:2048 nt
  s_waitcnt vmcnt(4)
  buffer_load_dwordx4 v[252:255], v2, s[32:35], s36 offen offset:3072 nt
  s_addk_i32 s36, 16384
  s_mov_b32 s46, 0xcccccccc
  s_mov_b32 s47, 0xcccccccc
  s_mov_b32 s48, 0xaaaaaaaa
  s_mov_b32 s49, 0xaaaaaaaa
  s_mov_b32 s62, 0x3db504f3
  v_mov_b32 v48, 0xff800000
  v_lshlrev_b32 v52, 2, v1
  s_lshl_b32 s50, s30, 12
  s_add_u32 s50, s50, 6912
  v_add_u32 v52, s50, v52
  v_lshlrev_b32 v53, 4, v1
  v_add_u32 v53, s51, v53
  v_and_b32 v3, 15, v1
  v_lshlrev_b32 v3, 5, v3
  v_mov_b32 v24, 0
  s_mov_b32 s37, 0x100000
L_qwait:
  ds_read_b32 v25, v24 offset:6720
  s_waitcnt lgkmcnt(0)
  v_readfirstlane_b32 s50, v25
  s_nop 0
  s_cmp_ge_u32 s50, 4
  s_cbranch_scc1 L_qready
  s_sleep 1
  s_sub_u32 s37, s37, 1
  s_cbranch_scc0 L_qwait
L_qready:
  ds_read_b128 v[24:27], v3 offset:4608
  ds_read_b128 v[28:31], v3 offset:4624
  ds_read_b128 v[32:35], v3 offset:5120
  ds_read_b128 v[36:39], v3 offset:5136
  s_waitcnt lgkmcnt(0)
  v_add_f32 v8, v24, v32
  v_add_f32 v9, v25, v33
  v_add_f32 v10, v26, v34
  v_add_f32 v11, v27, v35
  v_add_f32 v12, v28, v36
  v_add_f32 v13, v29, v37
  v_add_f32 v14, v30, v38
  v_add_f32 v15, v31, v39
  ds_read_b128 v[24:27], v3 offset:5632
  ds_read_b128 v[28:31], v3 offset:5648
  ds_read_b128 v[32:35], v3 offset:6144
  ds_read_b128 v[36:39], v3 offset:6160
  s_waitcnt lgkmcnt(0)
  v_add_f32 v24, v24, v32
  v_add_f32 v25, v25, v33
  v_add_f32 v26, v26, v34
  v_add_f32 v27, v27, v35
  v_add_f32 v28, v28, v36
  v_add_f32 v29, v29, v37
  v_add_f32 v30, v30, v38
  v_add_f32 v31, v31, v39
  v_add_f32 v8, v8, v24
  v_add_f32 v9, v9, v25
  v_add_f32 v10, v10, v26
  v_add_f32 v11, v11, v27
  v_add_f32 v12, v12, v28
  v_add_f32 v13, v13, v29
  v_add_f32 v14, v14, v30
  v_add_f32 v15, v15, v31
  v_cvt_pk_bf16_f32 v4, v8, v9
  v_cvt_pk_bf16_f32 v5, v10, v11
  v_cvt_pk_bf16_f32 v6, v12, v13
  v_cvt_pk_bf16_f32 v7, v14, v15
  v_dot2_f32_bf16 v8, v64, v4, 0
  v_dot2_f32_bf16 v9, v68, v4, 0
  v_dot2_f32_bf16 v10, v72, v4, 0
  v_dot2_f32_bf16 v11, v76, v4, 0
  v_dot2_f32_bf16 v8, v65, v5, v8
  v_dot2_f32_bf16 v9, v69, v5, v9
  v_dot2_f32_bf16 v10, v73, v5, v10
  v_dot2_f32_bf16 v11, v77, v5, v11
  v_dot2_f32_bf16 v8, v66, v6, v8
  v_dot2_f32_bf16 v9, v70, v6, v9
  v_dot2_f32_bf16 v10, v74, v6, v10
  v_dot2_f32_bf16 v11, v78, v6, v11
  v_dot2_f32_bf16 v8, v67, v7, v8
  v_dot2_f32_bf16 v9, v71, v7, v9
  v_dot2_f32_bf16 v10, v75, v7, v10
  v_dot2_f32_bf16 v11, v79, v7, v11
  s_waitcnt vmcnt(4)
  buffer_load_dwordx4 v[64:67], v2, s[32:35], s36 offen nt
  v_dot2_f32_bf16 v12, v80, v4, 0
  v_dot2_f32_bf16 v13, v84, v4, 0
  v_dot2_f32_bf16 v14, v88, v4, 0
  v_dot2_f32_bf16 v15, v92, v4, 0
  v_dot2_f32_bf16 v12, v81, v5, v12
  v_dot2_f32_bf16 v13, v85, v5, v13
  v_dot2_f32_bf16 v14, v89, v5, v14
  v_dot2_f32_bf16 v15, v93, v5, v15
  v_dot2_f32_bf16 v12, v82, v6, v12
  v_dot2_f32_bf16 v13, v86, v6, v13
  v_dot2_f32_bf16 v14, v90, v6, v14
  v_dot2_f32_bf16 v15, v94, v6, v15
  v_dot2_f32_bf16 v12, v83, v7, v12
  v_dot2_f32_bf16 v13, v87, v7, v13
  v_dot2_f32_bf16 v14, v91, v7, v14
  v_dot2_f32_bf16 v15, v95, v7, v15
  s_waitcnt vmcnt(4)
  buffer_load_dwordx4 v[68:71], v2, s[32:35], s36 offen offset:1024 nt
  v_dot2_f32_bf16 v16, v96, v4, 0
  v_dot2_f32_bf16 v17, v100, v4, 0
  v_dot2_f32_bf16 v18, v104, v4, 0
  v_dot2_f32_bf16 v19, v108, v4, 0
  v_dot2_f32_bf16 v16, v97, v5, v16
  v_dot2_f32_bf16 v17, v101, v5, v17
  v_dot2_f32_bf16 v18, v105, v5, v18
  v_dot2_f32_bf16 v19, v109, v5, v19
  v_dot2_f32_bf16 v16, v98, v6, v16
  v_dot2_f32_bf16 v17, v102, v6, v17
  v_dot2_f32_bf16 v18, v106, v6, v18
  v_dot2_f32_bf16 v19, v110, v6, v19
  v_dot2_f32_bf16 v16, v99, v7, v16
  v_dot2_f32_bf16 v17, v103, v7, v17
  v_dot2_f32_bf16 v18, v107, v7, v18
  v_dot2_f32_bf16 v19, v111, v7, v19
  ds_read_b128 v[24:27], v53 offset:0
  ds_read_b128 v[28:31], v53 offset:1024
  ds_read_b128 v[32:35], v53 offset:2048
  ds_read_b128 v[36:39], v53 offset:3072
  v_dot2_f32_bf16 v20, v112, v4, 0
  v_dot2_f32_bf16 v21, v116, v4, 0
  v_dot2_f32_bf16 v22, v120, v4, 0
  v_dot2_f32_bf16 v23, v124, v4, 0
  v_dot2_f32_bf16 v20, v113, v5, v20
  v_dot2_f32_bf16 v21, v117, v5, v21
  v_dot2_f32_bf16 v22, v121, v5, v22
  v_dot2_f32_bf16 v23, v125, v5, v23
  v_dot2_f32_bf16 v20, v114, v6, v20
  v_dot2_f32_bf16 v21, v118, v6, v21
  v_dot2_f32_bf16 v22, v122, v6, v22
  v_dot2_f32_bf16 v23, v126, v6, v23
  v_dot2_f32_bf16 v20, v115, v7, v20
  v_dot2_f32_bf16 v21, v119, v7, v21
  v_dot2_f32_bf16 v22, v123, v7, v22
  v_dot2_f32_bf16 v23, v127, v7, v23
  s_waitcnt vmcnt(4)
  buffer_load_dwordx4 v[72:75], v2, s[32:35], s36 offen offset:2048 nt
  v_add_f32_dpp v8, v8, v8 row_ror:8 row_mask:0xf bank_mask:0x3
  v_add_f32_dpp v8, v16, v16 row_ror:8 row_mask:0xf bank_mask:0xc
  v_add_f32_dpp v9, v9, v9 row_ror:8 row_mask:0xf bank_mask:0x3
  v_add_f32_dpp v9, v17, v17 row_ror:8 row_mask:0xf bank_mask:0xc
  v_add_f32_dpp v10, v10, v10 row_ror:8 row_mask:0xf bank_mask:0x3
  v_add_f32_dpp v10, v18, v18 row_ror:8 row_mask:0xf bank_mask:0xc
  v_add_f32_dpp v11, v11, v11 row_ror:8 row_mask:0xf bank_mask:0x3
  v_add_f32_dpp v11, v19, v19 row_ror:8 row_mask:0xf bank_mask:0xc
  v_add_f32_dpp v12, v12, v12 row_ror:8 row_mask:0xf bank_mask:0x3
  v_add_f32_dpp v12, v20, v20 row_ror:8 row_mask:0xf bank_mask:0xc
  v_add_f32_dpp v13, v13, v13 row_ror:8 row_mask:0xf bank_mask:0x3
  v_add_f32_dpp v13, v21, v21 row_ror:8 row_mask:0xf bank_mask:0xc
  v_add_f32_dpp v14, v14, v14 row_ror:8 row_mask:0xf bank_mask:0x3
  v_add_f32_dpp v14, v22, v22 row_ror:8 row_mask:0xf bank_mask:0xc
  v_add_f32_dpp v15, v15, v15 row_ror:8 row_mask:0xf bank_mask:0x3
  v_add_f32_dpp v15, v23, v23 row_ror:8 row_mask:0xf bank_mask:0xc
  v_add_f32_dpp v8, v8, v8 row_shl:4 row_mask:0xf bank_mask:0x5
  v_add_f32_dpp v8, v12, v12 row_shr:4 row_mask:0xf bank_mask:0xa
  v_add_f32_dpp v9, v9, v9 row_shl:4 row_mask:0xf bank_mask:0x5
  v_add_f32_dpp v9, v13, v13 row_shr:4 row_mask:0xf bank_mask:0xa
  v_add_f32_dpp v10, v10, v10 row_shl:4 row_mask:0xf bank_mask:0x5
  v_add_f32_dpp v10, v14, v14 row_shr:4 row_mask:0xf bank_mask:0xa
  v_add_f32_dpp v11, v11, v11 row_shl:4 row_mask:0xf bank_mask:0x5
  v_add_f32_dpp v11, v15, v15 row_shr:4 row_mask:0xf bank_mask:0xa
  s_waitcnt vmcnt(4)
  buffer_load_dwordx4 v[76:79], v2, s[32:35], s36 offen offset:3072 nt
  s_addk_i32 s36, 16384
  v_add_f32_dpp v8, v8, v8 quad_perm:[2,3,0,1] row_mask:0xf bank_mask:0xf
  v_add_f32_dpp v9, v9, v9 quad_perm:[2,3,0,1] row_mask:0xf bank_mask:0xf
  v_add_f32_dpp v10, v10, v10 quad_perm:[2,3,0,1] row_mask:0xf bank_mask:0xf
  v_add_f32_dpp v11, v11, v11 quad_perm:[2,3,0,1] row_mask:0xf bank_mask:0xf
  v_cndmask_b32 v8, v8, v10, s[46:47]
  v_cndmask_b32 v9, v9, v11, s[46:47]
  s_nop 0
  v_add_f32_dpp v8, v8, v8 quad_perm:[1,0,3,2] row_mask:0xf bank_mask:0xf
  v_add_f32_dpp v9, v9, v9 quad_perm:[1,0,3,2] row_mask:0xf bank_mask:0xf
  v_cndmask_b32 v8, v8, v9, s[48:49]
  v_cvt_pk_bf16_f32 v8, v8, v8
  v_and_b32 v8, s38, v8
  v_mul_f32 v8, s62, v8
  v_cvt_pk_bf16_f32 v8, v8, v8
  v_and_b32 v8, s38, v8
  ds_write_b32 v52, v8
  v_max_f32 v48, v48, v8
  v_add_u32 v52, 256, v52
  s_waitcnt vmcnt(4)
  buffer_load_dwordx4 v[80:83], v2, s[32:35], s36 offen nt
  ds_read_b128 v[40:43], v53 offset:4096
  ds_read_b128 v[44:47], v53 offset:5120
  ds_read_b128 v[56:59], v53 offset:6144
  ds_read_b128 v[60:63], v53 offset:7168
  s_waitcnt lgkmcnt(5)
  v_dot2_f32_bf16 v8, v24, v4, 0
  v_dot2_f32_bf16 v9, v28, v4, 0
  v_dot2_f32_bf16 v10, v32, v4, 0
  v_dot2_f32_bf16 v11, v36, v4, 0
  v_dot2_f32_bf16 v8, v25, v5, v8
  v_dot2_f32_bf16 v9, v29, v5, v9
  v_dot2_f32_bf16 v10, v33, v5, v10
  v_dot2_f32_bf16 v11, v37, v5, v11
  v_dot2_f32_bf16 v8, v26, v6, v8
  v_dot2_f32_bf16 v9, v30, v6, v9
  v_dot2_f32_bf16 v10, v34, v6, v10
  v_dot2_f32_bf16 v11, v38, v6, v11
  v_dot2_f32_bf16 v8, v27, v7, v8
  v_dot2_f32_bf16 v9, v31, v7, v9
  v_dot2_f32_bf16 v10, v35, v7, v10
  v_dot2_f32_bf16 v11, v39, v7, v11
  s_waitcnt vmcnt(4)
  buffer_load_dwordx4 v[84:87], v2, s[32:35], s36 offen offset:1024 nt
  ds_read_b128 v[24:27], v53 offset:8192
  ds_read_b128 v[28:31], v53 offset:9216
  ds_read_b128 v[32:35], v53 offset:10240
  ds_read_b128 v[36:39], v53 offset:11264
  s_waitcnt lgkmcnt(4)
  v_dot2_f32_bf16 v12, v40, v4, 0
  v_dot2_f32_bf16 v13, v44, v4, 0
  v_dot2_f32_bf16 v14, v56, v4, 0
  v_dot2_f32_bf16 v15, v60, v4, 0
  v_dot2_f32_bf16 v12, v41, v5, v12
  v_dot2_f32_bf16 v13, v45, v5, v13
  v_dot2_f32_bf16 v14, v57, v5, v14
  v_dot2_f32_bf16 v15, v61, v5, v15
  v_dot2_f32_bf16 v12, v42, v6, v12
  v_dot2_f32_bf16 v13, v46, v6, v13
  v_dot2_f32_bf16 v14, v58, v6, v14
  v_dot2_f32_bf16 v15, v62, v6, v15
  v_dot2_f32_bf16 v12, v43, v7, v12
  v_dot2_f32_bf16 v13, v47, v7, v13
  v_dot2_f32_bf16 v14, v59, v7, v14
  v_dot2_f32_bf16 v15, v63, v7, v15
  s_waitcnt vmcnt(4)
  buffer_load_dwordx4 v[88:91], v2, s[32:35], s36 offen offset:2048 nt
  ds_read_b128 v[40:43], v53 offset:12288
  ds_read_b128 v[44:47], v53 offset:13312
  ds_read_b128 v[56:59], v53 offset:14336
  ds_read_b128 v[60:63], v53 offset:15360
  s_waitcnt lgkmcnt(4)
  v_dot2_f32_bf16 v16, v24, v4, 0
  v_dot2_f32_bf16 v17, v28, v4, 0
  v_dot2_f32_bf16 v18, v32, v4, 0
  v_dot2_f32_bf16 v19, v36, v4, 0
  v_dot2_f32_bf16 v16, v25, v5, v16
  v_dot2_f32_bf16 v17, v29, v5, v17
  v_dot2_f32_bf16 v18, v33, v5, v18
  v_dot2_f32_bf16 v19, v37, v5, v19
  v_dot2_f32_bf16 v16, v26, v6, v16
  v_dot2_f32_bf16 v17, v30, v6, v17
  v_dot2_f32_bf16 v18, v34, v6, v18
  v_dot2_f32_bf16 v19, v38, v6, v19
  v_dot2_f32_bf16 v16, v27, v7, v16
  v_dot2_f32_bf16 v17, v31, v7, v17
  v_dot2_f32_bf16 v18, v35, v7, v18
  v_dot2_f32_bf16 v19, v39, v7, v19
  s_waitcnt vmcnt(4)
  buffer_load_dwordx4 v[92:95], v2, s[32:35], s36 offen offset:3072 nt
  s_addk_i32 s36, 16384
  ds_read_b128 v[24:27], v53 offset:16384
  ds_read_b128 v[28:31], v53 offset:17408
  ds_read_b128 v[32:35], v53 offset:18432
  ds_read_b128 v[36:39], v53 offset:19456
  s_waitcnt lgkmcnt(4)
  v_dot2_f32_bf16 v20, v40, v4, 0
  v_dot2_f32_bf16 v21, v44, v4, 0
  v_dot2_f32_bf16 v22, v56, v4, 0
  v_dot2_f32_bf16 v23, v60, v4, 0
  v_dot2_f32_bf16 v20, v41, v5, v20
  v_dot2_f32_bf16 v21, v45, v5, v21
  v_dot2_f32_bf16 v22, v57, v5, v22
  v_dot2_f32_bf16 v23, v61, v5, v23
  v_dot2_f32_bf16 v20, v42, v6, v20
  v_dot2_f32_bf16 v21, v46, v6, v21
  v_dot2_f32_bf16 v22, v58, v6, v22
  v_dot2_f32_bf16 v23, v62, v6, v23
  v_dot2_f32_bf16 v20, v43, v7, v20
  v_dot2_f32_bf16 v21, v47, v7, v21
  v_dot2_f32_bf16 v22, v59, v7, v22
  v_dot2_f32_bf16 v23, v63, v7, v23
  s_waitcnt vmcnt(4)
  buffer_load_dwordx4 v[96:99], v2, s[32:35], s36 offen nt
  v_add_f32_dpp v8, v8, v8 row_ror:8 row_mask:0xf bank_mask:0x3
  v_add_f32_dpp v8, v16, v16 row_ror:8 row_mask:0xf bank_mask:0xc
  v_add_f32_dpp v9, v9, v9 row_ror:8 row_mask:0xf bank_mask:0x3
  v_add_f32_dpp v9, v17, v17 row_ror:8 row_mask:0xf bank_mask:0xc
  v_add_f32_dpp v10, v10, v10 row_ror:8 row_mask:0xf bank_mask:0x3
  v_add_f32_dpp v10, v18, v18 row_ror:8 row_mask:0xf bank_mask:0xc
  v_add_f32_dpp v11, v11, v11 row_ror:8 row_mask:0xf bank_mask:0x3
  v_add_f32_dpp v11, v19, v19 row_ror:8 row_mask:0xf bank_mask:0xc
  v_add_f32_dpp v12, v12, v12 row_ror:8 row_mask:0xf bank_mask:0x3
  v_add_f32_dpp v12, v20, v20 row_ror:8 row_mask:0xf bank_mask:0xc
  v_add_f32_dpp v13, v13, v13 row_ror:8 row_mask:0xf bank_mask:0x3
  v_add_f32_dpp v13, v21, v21 row_ror:8 row_mask:0xf bank_mask:0xc
  v_add_f32_dpp v14, v14, v14 row_ror:8 row_mask:0xf bank_mask:0x3
  v_add_f32_dpp v14, v22, v22 row_ror:8 row_mask:0xf bank_mask:0xc
  v_add_f32_dpp v15, v15, v15 row_ror:8 row_mask:0xf bank_mask:0x3
  v_add_f32_dpp v15, v23, v23 row_ror:8 row_mask:0xf bank_mask:0xc
  v_add_f32_dpp v8, v8, v8 row_shl:4 row_mask:0xf bank_mask:0x5
  v_add_f32_dpp v8, v12, v12 row_shr:4 row_mask:0xf bank_mask:0xa
  v_add_f32_dpp v9, v9, v9 row_shl:4 row_mask:0xf bank_mask:0x5
  v_add_f32_dpp v9, v13, v13 row_shr:4 row_mask:0xf bank_mask:0xa
  v_add_f32_dpp v10, v10, v10 row_shl:4 row_mask:0xf bank_mask:0x5
  v_add_f32_dpp v10, v14, v14 row_shr:4 row_mask:0xf bank_mask:0xa
  v_add_f32_dpp v11, v11, v11 row_shl:4 row_mask:0xf bank_mask:0x5
  v_add_f32_dpp v11, v15, v15 row_shr:4 row_mask:0xf bank_mask:0xa
  s_waitcnt vmcnt(4)
  buffer_load_dwordx4 v[100:103], v2, s[32:35], s36 offen offset:1024 nt
  v_add_f32_dpp v8, v8, v8 quad_perm:[2,3,0,1] row_mask:0xf bank_mask:0xf
  v_add_f32_dpp v9, v9, v9 quad_perm:[2,3,0,1] row_mask:0xf bank_mask:0xf
  v_add_f32_dpp v10, v10, v10 quad_perm:[2,3,0,1] row_mask:0xf bank_mask:0xf
  v_add_f32_dpp v11, v11, v11 quad_perm:[2,3,0,1] row_mask:0xf bank_mask:0xf
  v_cndmask_b32 v8, v8, v10, s[46:47]
  v_cndmask_b32 v9, v9, v11, s[46:47]
  s_nop 0
  v_add_f32_dpp v8, v8, v8 quad_perm:[1,0,3,2] row_mask:0xf bank_mask:0xf
  v_add_f32_dpp v9, v9, v9 quad_perm:[1,0,3,2] row_mask:0xf bank_mask:0xf
  v_cndmask_b32 v8, v8, v9, s[48:49]
  v_cvt_pk_bf16_f32 v8, v8, v8
  v_and_b32 v8, s38, v8
  v_mul_f32 v8, s62, v8
  v_cvt_pk_bf16_f32 v8, v8, v8
  v_and_b32 v8, s38, v8
  ds_write_b32 v52, v8
  v_max_f32 v48, v48, v8
  v_add_u32 v52, 256, v52
  s_waitcnt vmcnt(4)
  buffer_load_dwordx4 v[104:107], v2, s[32:35], s36 offen offset:2048 nt
  ds_read_b128 v[40:43], v53 offset:20480
  ds_read_b128 v[44:47], v53 offset:21504
  ds_read_b128 v[56:59], v53 offset:22528
  ds_read_b128 v[60:63], v53 offset:23552
  s_waitcnt lgkmcnt(5)
  v_dot2_f32_bf16 v8, v24, v4, 0
  v_dot2_f32_bf16 v9, v28, v4, 0
  v_dot2_f32_bf16 v10, v32, v4, 0
  v_dot2_f32_bf16 v11, v36, v4, 0
  v_dot2_f32_bf16 v8, v25, v5, v8
  v_dot2_f32_bf16 v9, v29, v5, v9
  v_dot2_f32_bf16 v10, v33, v5, v10
  v_dot2_f32_bf16 v11, v37, v5, v11
  v_dot2_f32_bf16 v8, v26, v6, v8
  v_dot2_f32_bf16 v9, v30, v6, v9
  v_dot2_f32_bf16 v10, v34, v6, v10
  v_dot2_f32_bf16 v11, v38, v6, v11
  v_dot2_f32_bf16 v8, v27, v7, v8
  v_dot2_f32_bf16 v9, v31, v7, v9
  v_dot2_f32_bf16 v10, v35, v7, v10
  v_dot2_f32_bf16 v11, v39, v7, v11
  s_waitcnt vmcnt(4)
  buffer_load_dwordx4 v[108:111], v2, s[32:35], s36 offen offset:3072 nt
  s_addk_i32 s36, 16384
  ds_read_b128 v[24:27], v53 offset:24576
  ds_read_b128 v[28:31], v53 offset:25600
  ds_read_b128 v[32:35], v53 offset:26624
  ds_read_b128 v[36:39], v53 offset:27648
  s_waitcnt lgkmcnt(4)
  v_dot2_f32_bf16 v12, v40, v4, 0
  v_dot2_f32_bf16 v13, v44, v4, 0
  v_dot2_f32_bf16 v14, v56, v4, 0
  v_dot2_f32_bf16 v15, v60, v4, 0
  v_dot2_f32_bf16 v12, v41, v5, v12
  v_dot2_f32_bf16 v13, v45, v5, v13
  v_dot2_f32_bf16 v14, v57, v5, v14
  v_dot2_f32_bf16 v15, v61, v5, v15
  v_dot2_f32_bf16 v12, v42, v6, v12
  v_dot2_f32_bf16 v13, v46, v6, v13
  v_dot2_f32_bf16 v14, v58, v6, v14
  v_dot2_f32_bf16 v15, v62, v6, v15
  v_dot2_f32_bf16 v12, v43, v7, v12
  v_dot2_f32_bf16 v13, v47, v7, v13
  v_dot2_f32_bf16 v14, v59, v7, v14
  v_dot2_f32_bf16 v15, v63, v7, v15
  s_waitcnt vmcnt(4)
  buffer_load_dwordx4 v[112:115], v2, s[32:35], s36 offen nt
  ds_read_b128 v[40:43], v53 offset:28672
  ds_read_b128 v[44:47], v53 offset:29696
  ds_read_b128 v[56:59], v53 offset:30720
  ds_read_b128 v[60:63], v53 offset:31744
  s_waitcnt lgkmcnt(4)
  v_dot2_f32_bf16 v16, v24, v4, 0
  v_dot2_f32_bf16 v17, v28, v4, 0
  v_dot2_f32_bf16 v18, v32, v4, 0
  v_dot2_f32_bf16 v19, v36, v4, 0
  v_dot2_f32_bf16 v16, v25, v5, v16
  v_dot2_f32_bf16 v17, v29, v5, v17
  v_dot2_f32_bf16 v18, v33, v5, v18
  v_dot2_f32_bf16 v19, v37, v5, v19
  v_dot2_f32_bf16 v16, v26, v6, v16
  v_dot2_f32_bf16 v17, v30, v6, v17
  v_dot2_f32_bf16 v18, v34, v6, v18
  v_dot2_f32_bf16 v19, v38, v6, v19
  v_dot2_f32_bf16 v16, v27, v7, v16
  v_dot2_f32_bf16 v17, v31, v7, v17
  v_dot2_f32_bf16 v18, v35, v7, v18
  v_dot2_f32_bf16 v19, v39, v7, v19
  s_waitcnt lgkmcnt(0)
  v_dot2_f32_bf16 v20, v40, v4, 0
  v_dot2_f32_bf16 v21, v44, v4, 0
  v_dot2_f32_bf16 v22, v56, v4, 0
  v_dot2_f32_bf16 v23, v60, v4, 0
  v_dot2_f32_bf16 v20, v41, v5, v20
  v_dot2_f32_bf16 v21, v45, v5, v21
  v_dot2_f32_bf16 v22, v57, v5, v22
  v_dot2_f32_bf16 v23, v61, v5, v23
  v_dot2_f32_bf16 v20, v42, v6, v20
  v_dot2_f32_bf16 v21, v46, v6, v21
  v_dot2_f32_bf16 v22, v58, v6, v22
  v_dot2_f32_bf16 v23, v62, v6, v23
  v_dot2_f32_bf16 v20, v43, v7, v20
  v_dot2_f32_bf16 v21, v47, v7, v21
  v_dot2_f32_bf16 v22, v59, v7, v22
  v_dot2_f32_bf16 v23, v63, v7, v23
  s_waitcnt vmcnt(4)
  buffer_load_dwordx4 v[116:119], v2, s[32:35], s36 offen offset:1024 nt
  v_add_f32_dpp v8, v8, v8 row_ror:8 row_mask:0xf bank_mask:0x3
  v_add_f32_dpp v8, v16, v16 row_ror:8 row_mask:0xf bank_mask:0xc
  v_add_f32_dpp v9, v9, v9 row_ror:8 row_mask:0xf bank_mask:0x3
  v_add_f32_dpp v9, v17, v17 row_ror:8 row_mask:0xf bank_mask:0xc
  v_add_f32_dpp v10, v10, v10 row_ror:8 row_mask:0xf bank_mask:0x3
  v_add_f32_dpp v10, v18, v18 row_ror:8 row_mask:0xf bank_mask:0xc
  v_add_f32_dpp v11, v11, v11 row_ror:8 row_mask:0xf bank_mask:0x3
  v_add_f32_dpp v11, v19, v19 row_ror:8 row_mask:0xf bank_mask:0xc
  v_add_f32_dpp v12, v12, v12 row_ror:8 row_mask:0xf bank_mask:0x3
  v_add_f32_dpp v12, v20, v20 row_ror:8 row_mask:0xf bank_mask:0xc
  v_add_f32_dpp v13, v13, v13 row_ror:8 row_mask:0xf bank_mask:0x3
  v_add_f32_dpp v13, v21, v21 row_ror:8 row_mask:0xf bank_mask:0xc
  v_add_f32_dpp v14, v14, v14 row_ror:8 row_mask:0xf bank_mask:0x3
  v_add_f32_dpp v14, v22, v22 row_ror:8 row_mask:0xf bank_mask:0xc
  v_add_f32_dpp v15, v15, v15 row_ror:8 row_mask:0xf bank_mask:0x3
  v_add_f32_dpp v15, v23, v23 row_ror:8 row_mask:0xf bank_mask:0xc
  v_add_f32_dpp v8, v8, v8 row_shl:4 row_mask:0xf bank_mask:0x5
  v_add_f32_dpp v8, v12, v12 row_shr:4 row_mask:0xf bank_mask:0xa
  v_add_f32_dpp v9, v9, v9 row_shl:4 row_mask:0xf bank_mask:0x5
  v_add_f32_dpp v9, v13, v13 row_shr:4 row_mask:0xf bank_mask:0xa
  v_add_f32_dpp v10, v10, v10 row_shl:4 row_mask:0xf bank_mask:0x5
  v_add_f32_dpp v10, v14, v14 row_shr:4 row_mask:0xf bank_mask:0xa
  v_add_f32_dpp v11, v11, v11 row_shl:4 row_mask:0xf bank_mask:0x5
  v_add_f32_dpp v11, v15, v15 row_shr:4 row_mask:0xf bank_mask:0xa
  s_waitcnt vmcnt(4)
  buffer_load_dwordx4 v[120:123], v2, s[32:35], s36 offen offset:2048 nt
  v_add_f32_dpp v8, v8, v8 quad_perm:[2,3,0,1] row_mask:0xf bank_mask:0xf
  v_add_f32_dpp v9, v9, v9 quad_perm:[2,3,0,1] row_mask:0xf bank_mask:0xf
  v_add_f32_dpp v10, v10, v10 quad_perm:[2,3,0,1] row_mask:0xf bank_mask:0xf
  v_add_f32_dpp v11, v11, v11 quad_perm:[2,3,0,1] row_mask:0xf bank_mask:0xf
  v_cndmask_b32 v8, v8, v10, s[46:47]
  v_cndmask_b32 v9, v9, v11, s[46:47]
  s_nop 0
  v_add_f32_dpp v8, v8, v8 quad_perm:[1,0,3,2] row_mask:0xf bank_mask:0xf
  v_add_f32_dpp v9, v9, v9 quad_perm:[1,0,3,2] row_mask:0xf bank_mask:0xf
  v_cndmask_b32 v8, v8, v9, s[48:49]
  v_cvt_pk_bf16_f32 v8, v8, v8
  v_and_b32 v8, s38, v8
  v_mul_f32 v8, s62, v8
  v_cvt_pk_bf16_f32 v8, v8, v8
  v_and_b32 v8, s38, v8
  ds_write_b32 v52, v8
  v_max_f32 v48, v48, v8
  v_add_u32 v52, 256, v52
  s_waitcnt vmcnt(4)
  buffer_load_dwordx4 v[124:127], v2, s[32:35], s36 offen offset:3072 nt
  s_addk_i32 s36, 16384
  v_dot2_f32_bf16 v8, v128, v4, 0
  v_dot2_f32_bf16 v9, v132, v4, 0
  v_dot2_f32_bf16 v10, v136, v4, 0
  v_dot2_f32_bf16 v11, v140, v4, 0
  v_dot2_f32_bf16 v8, v129, v5, v8
  v_dot2_f32_bf16 v9, v133, v5, v9
  v_dot2_f32_bf16 v10, v137, v5, v10
  v_dot2_f32_bf16 v11, v141, v5, v11
  v_dot2_f32_bf16 v8, v130, v6, v8
  v_dot2_f32_bf16 v9, v134, v6, v9
  v_dot2_f32_bf16 v10, v138, v6, v10
  v_dot2_f32_bf16 v11, v142, v6, v11
  v_dot2_f32_bf16 v8, v131, v7, v8
  v_dot2_f32_bf16 v9, v135, v7, v9
  v_dot2_f32_bf16 v10, v139, v7, v10
  v_dot2_f32_bf16 v11, v143, v7, v11
  s_waitcnt vmcnt(4)
  buffer_load_dwordx4 v[128:131], v2, s[32:35], s36 offen nt
  v_dot2_f32_bf16 v12, v144, v4, 0
  v_dot2_f32_bf16 v13, v148, v4, 0
  v_dot2_f32_bf16 v14, v152, v4, 0
  v_dot2_f32_bf16 v15, v156, v4, 0
  v_dot2_f32_bf16 v12, v145, v5, v12
  v_dot2_f32_bf16 v13, v149, v5, v13
  v_dot2_f32_bf16 v14, v153, v5, v14
  v_dot2_f32_bf16 v15, v157, v5, v15
  v_dot2_f32_bf16 v12, v146, v6, v12
  v_dot2_f32_bf16 v13, v150, v6, v13
  v_dot2_f32_bf16 v14, v154, v6, v14
  v_dot2_f32_bf16 v15, v158, v6, v15
  v_dot2_f32_bf16 v12, v147, v7, v12
  v_dot2_f32_bf16 v13, v151, v7, v13
  v_dot2_f32_bf16 v14, v155, v7, v14
  v_dot2_f32_bf16 v15, v159, v7, v15
  s_waitcnt vmcnt(4)
  buffer_load_dwordx4 v[132:135], v2, s[32:35], s36 offen offset:1024 nt
  v_dot2_f32_bf16 v16, v160, v4, 0
  v_dot2_f32_bf16 v17, v164, v4, 0
  v_dot2_f32_bf16 v18, v168, v4, 0
  v_dot2_f32_bf16 v19, v172, v4, 0
  v_dot2_f32_bf16 v16, v161, v5, v16
  v_dot2_f32_bf16 v17, v165, v5, v17
  v_dot2_f32_bf16 v18, v169, v5, v18
  v_dot2_f32_bf16 v19, v173, v5, v19
  v_dot2_f32_bf16 v16, v162, v6, v16
  v_dot2_f32_bf16 v17, v166, v6, v17
  v_dot2_f32_bf16 v18, v170, v6, v18
  v_dot2_f32_bf16 v19, v174, v6, v19
  v_dot2_f32_bf16 v16, v163, v7, v16
  v_dot2_f32_bf16 v17, v167, v7, v17
  v_dot2_f32_bf16 v18, v171, v7, v18
  v_dot2_f32_bf16 v19, v175, v7, v19
  s_waitcnt vmcnt(4)
  buffer_load_dwordx4 v[136:139], v2, s[32:35], s36 offen offset:2048 nt
  v_dot2_f32_bf16 v20, v176, v4, 0
  v_dot2_f32_bf16 v21, v180, v4, 0
  v_dot2_f32_bf16 v22, v184, v4, 0
  v_dot2_f32_bf16 v23, v188, v4, 0
  v_dot2_f32_bf16 v20, v177, v5, v20
  v_dot2_f32_bf16 v21, v181, v5, v21
  v_dot2_f32_bf16 v22, v185, v5, v22
  v_dot2_f32_bf16 v23, v189, v5, v23
  v_dot2_f32_bf16 v20, v178, v6, v20
  v_dot2_f32_bf16 v21, v182, v6, v21
  v_dot2_f32_bf16 v22, v186, v6, v22
  v_dot2_f32_bf16 v23, v190, v6, v23
  v_dot2_f32_bf16 v20, v179, v7, v20
  v_dot2_f32_bf16 v21, v183, v7, v21
  v_dot2_f32_bf16 v22, v187, v7, v22
  v_dot2_f32_bf16 v23, v191, v7, v23
  v_add_f32_dpp v8, v8, v8 row_ror:8 row_mask:0xf bank_mask:0x3
  v_add_f32_dpp v8, v16, v16 row_ror:8 row_mask:0xf bank_mask:0xc
  v_add_f32_dpp v9, v9, v9 row_ror:8 row_mask:0xf bank_mask:0x3
  v_add_f32_dpp v9, v17, v17 row_ror:8 row_mask:0xf bank_mask:0xc
  v_add_f32_dpp v10, v10, v10 row_ror:8 row_mask:0xf bank_mask:0x3
  v_add_f32_dpp v10, v18, v18 row_ror:8 row_mask:0xf bank_mask:0xc
  v_add_f32_dpp v11, v11, v11 row_ror:8 row_mask:0xf bank_mask:0x3
  v_add_f32_dpp v11, v19, v19 row_ror:8 row_mask:0xf bank_mask:0xc
  v_add_f32_dpp v12, v12, v12 row_ror:8 row_mask:0xf bank_mask:0x3
  v_add_f32_dpp v12, v20, v20 row_ror:8 row_mask:0xf bank_mask:0xc
  v_add_f32_dpp v13, v13, v13 row_ror:8 row_mask:0xf bank_mask:0x3
  v_add_f32_dpp v13, v21, v21 row_ror:8 row_mask:0xf bank_mask:0xc
  v_add_f32_dpp v14, v14, v14 row_ror:8 row_mask:0xf bank_mask:0x3
  v_add_f32_dpp v14, v22, v22 row_ror:8 row_mask:0xf bank_mask:0xc
  v_add_f32_dpp v15, v15, v15 row_ror:8 row_mask:0xf bank_mask:0x3
  v_add_f32_dpp v15, v23, v23 row_ror:8 row_mask:0xf bank_mask:0xc
  v_add_f32_dpp v8, v8, v8 row_shl:4 row_mask:0xf bank_mask:0x5
  v_add_f32_dpp v8, v12, v12 row_shr:4 row_mask:0xf bank_mask:0xa
  v_add_f32_dpp v9, v9, v9 row_shl:4 row_mask:0xf bank_mask:0x5
  v_add_f32_dpp v9, v13, v13 row_shr:4 row_mask:0xf bank_mask:0xa
  v_add_f32_dpp v10, v10, v10 row_shl:4 row_mask:0xf bank_mask:0x5
  v_add_f32_dpp v10, v14, v14 row_shr:4 row_mask:0xf bank_mask:0xa
  v_add_f32_dpp v11, v11, v11 row_shl:4 row_mask:0xf bank_mask:0x5
  v_add_f32_dpp v11, v15, v15 row_shr:4 row_mask:0xf bank_mask:0xa
  s_waitcnt vmcnt(4)
  buffer_load_dwordx4 v[140:143], v2, s[32:35], s36 offen offset:3072 nt
  s_addk_i32 s36, 16384
  v_add_f32_dpp v8, v8, v8 quad_perm:[2,3,0,1] row_mask:0xf bank_mask:0xf
  v_add_f32_dpp v9, v9, v9 quad_perm:[2,3,0,1] row_mask:0xf bank_mask:0xf
  v_add_f32_dpp v10, v10, v10 quad_perm:[2,3,0,1] row_mask:0xf bank_mask:0xf
  v_add_f32_dpp v11, v11, v11 quad_perm:[2,3,0,1] row_mask:0xf bank_mask:0xf
  v_cndmask_b32 v8, v8, v10, s[46:47]
  v_cndmask_b32 v9, v9, v11, s[46:47]
  s_nop 0
  v_add_f32_dpp v8, v8, v8 quad_perm:[1,0,3,2] row_mask:0xf bank_mask:0xf
  v_add_f32_dpp v9, v9, v9 quad_perm:[1,0,3,2] row_mask:0xf bank_mask:0xf
  v_cndmask_b32 v8, v8, v9, s[48:49]
  v_cvt_pk_bf16_f32 v8, v8, v8
  v_and_b32 v8, s38, v8
  v_mul_f32 v8, s62, v8
  v_cvt_pk_bf16_f32 v8, v8, v8
  v_and_b32 v8, s38, v8
  ds_write_b32 v52, v8
  v_max_f32 v48, v48, v8
  v_add_u32 v52, 256, v52
  s_waitcnt vmcnt(4)
  buffer_load_dwordx4 v[144:147], v2, s[32:35], s36 offen nt
  v_dot2_f32_bf16 v8, v192, v4, 0
  v_dot2_f32_bf16 v9, v196, v4, 0
  v_dot2_f32_bf16 v10, v200, v4, 0
  v_dot2_f32_bf16 v11, v204, v4, 0
  v_dot2_f32_bf16 v8, v193, v5, v8
  v_dot2_f32_bf16 v9, v197, v5, v9
  v_dot2_f32_bf16 v10, v201, v5, v10
  v_dot2_f32_bf16 v11, v205, v5, v11
  v_dot2_f32_bf16 v8, v194, v6, v8
  v_dot2_f32_bf16 v9, v198, v6, v9
  v_dot2_f32_bf16 v10, v202, v6, v10
  v_dot2_f32_bf16 v11, v206, v6, v11
  v_dot2_f32_bf16 v8, v195, v7, v8
  v_dot2_f32_bf16 v9, v199, v7, v9
  v_dot2_f32_bf16 v10, v203, v7, v10
  v_dot2_f32_bf16 v11, v207, v7, v11
  s_waitcnt vmcnt(4)
  buffer_load_dwordx4 v[148:151], v2, s[32:35], s36 offen offset:1024 nt
  s_waitcnt vmcnt(4)
  buffer_load_dwordx4 v[152:155], v2, s[32:35], s36 offen offset:2048 nt
  v_dot2_f32_bf16 v12, v208, v4, 0
  v_dot2_f32_bf16 v13, v212, v4, 0
  v_dot2_f32_bf16 v14, v216, v4, 0
  v_dot2_f32_bf16 v15, v220, v4, 0
  v_dot2_f32_bf16 v12, v209, v5, v12
  v_dot2_f32_bf16 v13, v213, v5, v13
  v_dot2_f32_bf16 v14, v217, v5, v14
  v_dot2_f32_bf16 v15, v221, v5, v15
  v_dot2_f32_bf16 v12, v210, v6, v12
  v_dot2_f32_bf16 v13, v214, v6, v13
  v_dot2_f32_bf16 v14, v218, v6, v14
  v_dot2_f32_bf16 v15, v222, v6, v15
  v_dot2_f32_bf16 v12, v211, v7, v12
  v_dot2_f32_bf16 v13, v215, v7, v13
  v_dot2_f32_bf16 v14, v219, v7, v14
  v_dot2_f32_bf16 v15, v223, v7, v15
  v_dot2_f32_bf16 v16, v224, v4, 0
  v_dot2_f32_bf16 v17, v228, v4, 0
  v_dot2_f32_bf16 v18, v232, v4, 0
  v_dot2_f32_bf16 v19, v236, v4, 0
  v_dot2_f32_bf16 v16, v225, v5, v16
  v_dot2_f32_bf16 v17, v229, v5, v17
  v_dot2_f32_bf16 v18, v233, v5, v18
  v_dot2_f32_bf16 v19, v237, v5, v19
  v_dot2_f32_bf16 v16, v226, v6, v16
  v_dot2_f32_bf16 v17, v230, v6, v17
  v_dot2_f32_bf16 v18, v234, v6, v18
  v_dot2_f32_bf16 v19, v238, v6, v19
  v_dot2_f32_bf16 v16, v227, v7, v16
  v_dot2_f32_bf16 v17, v231, v7, v17
  v_dot2_f32_bf16 v18, v235, v7, v18
  v_dot2_f32_bf16 v19, v239, v7, v19
  s_waitcnt vmcnt(4)
  buffer_load_dwordx4 v[156:159], v2, s[32:35], s36 offen offset:3072 nt
  s_addk_i32 s36, 16384
  v_dot2_f32_bf16 v20, v240, v4, 0
  v_dot2_f32_bf16 v21, v244, v4, 0
  v_dot2_f32_bf16 v22, v248, v4, 0
  v_dot2_f32_bf16 v23, v252, v4, 0
  v_dot2_f32_bf16 v20, v241, v5, v20
  v_dot2_f32_bf16 v21, v245, v5, v21
  v_dot2_f32_bf16 v22, v249, v5, v22
  v_dot2_f32_bf16 v23, v253, v5, v23
  v_dot2_f32_bf16 v20, v242, v6, v20
  v_dot2_f32_bf16 v21, v246, v6, v21
  v_dot2_f32_bf16 v22, v250, v6, v22
  v_dot2_f32_bf16 v23, v254, v6, v23
  v_dot2_f32_bf16 v20, v243, v7, v20
  v_dot2_f32_bf16 v21, v247, v7, v21
  v_dot2_f32_bf16 v22, v251, v7, v22
  v_dot2_f32_bf16 v23, v255, v7, v23
  s_waitcnt vmcnt(4)
  buffer_load_dwordx4 v[160:163], v2, s[32:35], s36 offen nt
  v_add_f32_dpp v8, v8, v8 row_ror:8 row_mask:0xf bank_mask:0x3
  v_add_f32_dpp v8, v16, v16 row_ror:8 row_mask:0xf bank_mask:0xc
  v_add_f32_dpp v9, v9, v9 row_ror:8 row_mask:0xf bank_mask:0x3
  v_add_f32_dpp v9, v17, v17 row_ror:8 row_mask:0xf bank_mask:0xc
  v_add_f32_dpp v10, v10, v10 row_ror:8 row_mask:0xf bank_mask:0x3
  v_add_f32_dpp v10, v18, v18 row_ror:8 row_mask:0xf bank_mask:0xc
  v_add_f32_dpp v11, v11, v11 row_ror:8 row_mask:0xf bank_mask:0x3
  v_add_f32_dpp v11, v19, v19 row_ror:8 row_mask:0xf bank_mask:0xc
  v_add_f32_dpp v12, v12, v12 row_ror:8 row_mask:0xf bank_mask:0x3
  v_add_f32_dpp v12, v20, v20 row_ror:8 row_mask:0xf bank_mask:0xc
  v_add_f32_dpp v13, v13, v13 row_ror:8 row_mask:0xf bank_mask:0x3
  v_add_f32_dpp v13, v21, v21 row_ror:8 row_mask:0xf bank_mask:0xc
  v_add_f32_dpp v14, v14, v14 row_ror:8 row_mask:0xf bank_mask:0x3
  v_add_f32_dpp v14, v22, v22 row_ror:8 row_mask:0xf bank_mask:0xc
  v_add_f32_dpp v15, v15, v15 row_ror:8 row_mask:0xf bank_mask:0x3
  v_add_f32_dpp v15, v23, v23 row_ror:8 row_mask:0xf bank_mask:0xc
  v_add_f32_dpp v8, v8, v8 row_shl:4 row_mask:0xf bank_mask:0x5
  v_add_f32_dpp v8, v12, v12 row_shr:4 row_mask:0xf bank_mask:0xa
  v_add_f32_dpp v9, v9, v9 row_shl:4 row_mask:0xf bank_mask:0x5
  v_add_f32_dpp v9, v13, v13 row_shr:4 row_mask:0xf bank_mask:0xa
  v_add_f32_dpp v10, v10, v10 row_shl:4 row_mask:0xf bank_mask:0x5
  v_add_f32_dpp v10, v14, v14 row_shr:4 row_mask:0xf bank_mask:0xa
  v_add_f32_dpp v11, v11, v11 row_shl:4 row_mask:0xf bank_mask:0x5
  v_add_f32_dpp v11, v15, v15 row_shr:4 row_mask:0xf bank_mask:0xa
  s_waitcnt vmcnt(4)
  buffer_load_dwordx4 v[164:167], v2, s[32:35], s36 offen offset:1024 nt
  v_add_f32_dpp v8, v8, v8 quad_perm:[2,3,0,1] row_mask:0xf bank_mask:0xf
  v_add_f32_dpp v9, v9, v9 quad_perm:[2,3,0,1] row_mask:0xf bank_mask:0xf
  v_add_f32_dpp v10, v10, v10 quad_perm:[2,3,0,1] row_mask:0xf bank_mask:0xf
  v_add_f32_dpp v11, v11, v11 quad_perm:[2,3,0,1] row_mask:0xf bank_mask:0xf
  v_cndmask_b32 v8, v8, v10, s[46:47]
  v_cndmask_b32 v9, v9, v11, s[46:47]
  s_nop 0
  v_add_f32_dpp v8, v8, v8 quad_perm:[1,0,3,2] row_mask:0xf bank_mask:0xf
  v_add_f32_dpp v9, v9, v9 quad_perm:[1,0,3,2] row_mask:0xf bank_mask:0xf
  v_cndmask_b32 v8, v8, v9, s[48:49]
  v_cvt_pk_bf16_f32 v8, v8, v8
  v_and_b32 v8, s38, v8
  v_mul_f32 v8, s62, v8
  v_cvt_pk_bf16_f32 v8, v8, v8
  v_and_b32 v8, s38, v8
  ds_write_b32 v52, v8
  v_max_f32 v48, v48, v8
  v_add_u32 v52, 256, v52
  s_waitcnt vmcnt(4)
  buffer_load_dwordx4 v[168:171], v2, s[32:35], s36 offen offset:2048 nt
  v_dot2_f32_bf16 v8, v64, v4, 0
  v_dot2_f32_bf16 v9, v68, v4, 0
  v_dot2_f32_bf16 v10, v72, v4, 0
  v_dot2_f32_bf16 v11, v76, v4, 0
  v_dot2_f32_bf16 v8, v65, v5, v8
  v_dot2_f32_bf16 v9, v69, v5, v9
  v_dot2_f32_bf16 v10, v73, v5, v10
  v_dot2_f32_bf16 v11, v77, v5, v11
  v_dot2_f32_bf16 v8, v66, v6, v8
  v_dot2_f32_bf16 v9, v70, v6, v9
  v_dot2_f32_bf16 v10, v74, v6, v10
  v_dot2_f32_bf16 v11, v78, v6, v11
  v_dot2_f32_bf16 v8, v67, v7, v8
  v_dot2_f32_bf16 v9, v71, v7, v9
  v_dot2_f32_bf16 v10, v75, v7, v10
  v_dot2_f32_bf16 v11, v79, v7, v11
  s_waitcnt vmcnt(4)
  buffer_load_dwordx4 v[172:175], v2, s[32:35], s36 offen offset:3072 nt
  s_addk_i32 s36, 16384
  v_dot2_f32_bf16 v12, v80, v4, 0
  v_dot2_f32_bf16 v13, v84, v4, 0
  v_dot2_f32_bf16 v14, v88, v4, 0
  v_dot2_f32_bf16 v15, v92, v4, 0
  v_dot2_f32_bf16 v12, v81, v5, v12
  v_dot2_f32_bf16 v13, v85, v5, v13
  v_dot2_f32_bf16 v14, v89, v5, v14
  v_dot2_f32_bf16 v15, v93, v5, v15
  v_dot2_f32_bf16 v12, v82, v6, v12
  v_dot2_f32_bf16 v13, v86, v6, v13
  v_dot2_f32_bf16 v14, v90, v6, v14
  v_dot2_f32_bf16 v15, v94, v6, v15
  v_dot2_f32_bf16 v12, v83, v7, v12
  v_dot2_f32_bf16 v13, v87, v7, v13
  v_dot2_f32_bf16 v14, v91, v7, v14
  v_dot2_f32_bf16 v15, v95, v7, v15
  s_waitcnt vmcnt(4)
  buffer_load_dwordx4 v[176:179], v2, s[32:35], s36 offen nt
  v_dot2_f32_bf16 v16, v96, v4, 0
  v_dot2_f32_bf16 v17, v100, v4, 0
  v_dot2_f32_bf16 v18, v104, v4, 0
  v_dot2_f32_bf16 v19, v108, v4, 0
  v_dot2_f32_bf16 v16, v97, v5, v16
  v_dot2_f32_bf16 v17, v101, v5, v17
  v_dot2_f32_bf16 v18, v105, v5, v18
  v_dot2_f32_bf16 v19, v109, v5, v19
  v_dot2_f32_bf16 v16, v98, v6, v16
  v_dot2_f32_bf16 v17, v102, v6, v17
  v_dot2_f32_bf16 v18, v106, v6, v18
  v_dot2_f32_bf16 v19, v110, v6, v19
  v_dot2_f32_bf16 v16, v99, v7, v16
  v_dot2_f32_bf16 v17, v103, v7, v17
  v_dot2_f32_bf16 v18, v107, v7, v18
  v_dot2_f32_bf16 v19, v111, v7, v19
  s_waitcnt vmcnt(4)
  buffer_load_dwordx4 v[180:183], v2, s[32:35], s36 offen offset:1024 nt
  v_dot2_f32_bf16 v20, v112, v4, 0
  v_dot2_f32_bf16 v21, v116, v4, 0
  v_dot2_f32_bf16 v22, v120, v4, 0
  v_dot2_f32_bf16 v23, v124, v4, 0
  v_dot2_f32_bf16 v20, v113, v5, v20
  v_dot2_f32_bf16 v21, v117, v5, v21
  v_dot2_f32_bf16 v22, v121, v5, v22
  v_dot2_f32_bf16 v23, v125, v5, v23
  v_dot2_f32_bf16 v20, v114, v6, v20
  v_dot2_f32_bf16 v21, v118, v6, v21
  v_dot2_f32_bf16 v22, v122, v6, v22
  v_dot2_f32_bf16 v23, v126, v6, v23
  v_dot2_f32_bf16 v20, v115, v7, v20
  v_dot2_f32_bf16 v21, v119, v7, v21
  v_dot2_f32_bf16 v22, v123, v7, v22
  v_dot2_f32_bf16 v23, v127, v7, v23
  v_add_f32_dpp v8, v8, v8 row_ror:8 row_mask:0xf bank_mask:0x3
  v_add_f32_dpp v8, v16, v16 row_ror:8 row_mask:0xf bank_mask:0xc
  v_add_f32_dpp v9, v9, v9 row_ror:8 row_mask:0xf bank_mask:0x3
  v_add_f32_dpp v9, v17, v17 row_ror:8 row_mask:0xf bank_mask:0xc
  v_add_f32_dpp v10, v10, v10 row_ror:8 row_mask:0xf bank_mask:0x3
  v_add_f32_dpp v10, v18, v18 row_ror:8 row_mask:0xf bank_mask:0xc
  v_add_f32_dpp v11, v11, v11 row_ror:8 row_mask:0xf bank_mask:0x3
  v_add_f32_dpp v11, v19, v19 row_ror:8 row_mask:0xf bank_mask:0xc
  v_add_f32_dpp v12, v12, v12 row_ror:8 row_mask:0xf bank_mask:0x3
  v_add_f32_dpp v12, v20, v20 row_ror:8 row_mask:0xf bank_mask:0xc
  v_add_f32_dpp v13, v13, v13 row_ror:8 row_mask:0xf bank_mask:0x3
  v_add_f32_dpp v13, v21, v21 row_ror:8 row_mask:0xf bank_mask:0xc
  v_add_f32_dpp v14, v14, v14 row_ror:8 row_mask:0xf bank_mask:0x3
  v_add_f32_dpp v14, v22, v22 row_ror:8 row_mask:0xf bank_mask:0xc
  v_add_f32_dpp v15, v15, v15 row_ror:8 row_mask:0xf bank_mask:0x3
  v_add_f32_dpp v15, v23, v23 row_ror:8 row_mask:0xf bank_mask:0xc
  v_add_f32_dpp v8, v8, v8 row_shl:4 row_mask:0xf bank_mask:0x5
  v_add_f32_dpp v8, v12, v12 row_shr:4 row_mask:0xf bank_mask:0xa
  v_add_f32_dpp v9, v9, v9 row_shl:4 row_mask:0xf bank_mask:0x5
  v_add_f32_dpp v9, v13, v13 row_shr:4 row_mask:0xf bank_mask:0xa
  v_add_f32_dpp v10, v10, v10 row_shl:4 row_mask:0xf bank_mask:0x5
  v_add_f32_dpp v10, v14, v14 row_shr:4 row_mask:0xf bank_mask:0xa
  v_add_f32_dpp v11, v11, v11 row_shl:4 row_mask:0xf bank_mask:0x5
  v_add_f32_dpp v11, v15, v15 row_shr:4 row_mask:0xf bank_mask:0xa
  s_waitcnt vmcnt(4)
  buffer_load_dwordx4 v[184:187], v2, s[32:35], s36 offen offset:2048 nt
  v_add_f32_dpp v8, v8, v8 quad_perm:[2,3,0,1] row_mask:0xf bank_mask:0xf
  v_add_f32_dpp v9, v9, v9 quad_perm:[2,3,0,1] row_mask:0xf bank_mask:0xf
  v_add_f32_dpp v10, v10, v10 quad_perm:[2,3,0,1] row_mask:0xf bank_mask:0xf
  v_add_f32_dpp v11, v11, v11 quad_perm:[2,3,0,1] row_mask:0xf bank_mask:0xf
  v_cndmask_b32 v8, v8, v10, s[46:47]
  v_cndmask_b32 v9, v9, v11, s[46:47]
  s_nop 0
  v_add_f32_dpp v8, v8, v8 quad_perm:[1,0,3,2] row_mask:0xf bank_mask:0xf
  v_add_f32_dpp v9, v9, v9 quad_perm:[1,0,3,2] row_mask:0xf bank_mask:0xf
  v_cndmask_b32 v8, v8, v9, s[48:49]
  v_cvt_pk_bf16_f32 v8, v8, v8
  v_and_b32 v8, s38, v8
  v_mul_f32 v8, s62, v8
  v_cvt_pk_bf16_f32 v8, v8, v8
  v_and_b32 v8, s38, v8
  ds_write_b32 v52, v8
  v_max_f32 v48, v48, v8
  v_add_u32 v52, 256, v52
  s_waitcnt vmcnt(4)
  buffer_load_dwordx4 v[188:191], v2, s[32:35], s36 offen offset:3072 nt
  s_addk_i32 s36, 16384
  v_dot2_f32_bf16 v8, v128, v4, 0
  v_dot2_f32_bf16 v9, v132, v4, 0
  v_dot2_f32_bf16 v10, v136, v4, 0
  v_dot2_f32_bf16 v11, v140, v4, 0
  v_dot2_f32_bf16 v8, v129, v5, v8
  v_dot2_f32_bf16 v9, v133, v5, v9
  v_dot2_f32_bf16 v10, v137, v5, v10
  v_dot2_f32_bf16 v11, v141, v5, v11
  v_dot2_f32_bf16 v8, v130, v6, v8
  v_dot2_f32_bf16 v9, v134, v6, v9
  v_dot2_f32_bf16 v10, v138, v6, v10
  v_dot2_f32_bf16 v11, v142, v6, v11
  v_dot2_f32_bf16 v8, v131, v7, v8
  v_dot2_f32_bf16 v9, v135, v7, v9
  v_dot2_f32_bf16 v10, v139, v7, v10
  v_dot2_f32_bf16 v11, v143, v7, v11
  s_waitcnt vmcnt(4)
  buffer_load_dwordx4 v[64:67], v2, s[32:35], s36 offen nt
  s_waitcnt vmcnt(4)
  buffer_load_dwordx4 v[68:71], v2, s[32:35], s36 offen offset:1024 nt
  v_dot2_f32_bf16 v12, v144, v4, 0
  v_dot2_f32_bf16 v13, v148, v4, 0
  v_dot2_f32_bf16 v14, v152, v4, 0
  v_dot2_f32_bf16 v15, v156, v4, 0
  v_dot2_f32_bf16 v12, v145, v5, v12
  v_dot2_f32_bf16 v13, v149, v5, v13
  v_dot2_f32_bf16 v14, v153, v5, v14
  v_dot2_f32_bf16 v15, v157, v5, v15
  v_dot2_f32_bf16 v12, v146, v6, v12
  v_dot2_f32_bf16 v13, v150, v6, v13
  v_dot2_f32_bf16 v14, v154, v6, v14
  v_dot2_f32_bf16 v15, v158, v6, v15
  v_dot2_f32_bf16 v12, v147, v7, v12
  v_dot2_f32_bf16 v13, v151, v7, v13
  v_dot2_f32_bf16 v14, v155, v7, v14
  v_dot2_f32_bf16 v15, v159, v7, v15
  v_dot2_f32_bf16 v16, v160, v4, 0
  v_dot2_f32_bf16 v17, v164, v4, 0
  v_dot2_f32_bf16 v18, v168, v4, 0
  v_dot2_f32_bf16 v19, v172, v4, 0
  v_dot2_f32_bf16 v16, v161, v5, v16
  v_dot2_f32_bf16 v17, v165, v5, v17
  v_dot2_f32_bf16 v18, v169, v5, v18
  v_dot2_f32_bf16 v19, v173, v5, v19
  v_dot2_f32_bf16 v16, v162, v6, v16
  v_dot2_f32_bf16 v17, v166, v6, v17
  v_dot2_f32_bf16 v18, v170, v6, v18
  v_dot2_f32_bf16 v19, v174, v6, v19
  v_dot2_f32_bf16 v16, v163, v7, v16
  v_dot2_f32_bf16 v17, v167, v7, v17
  v_dot2_f32_bf16 v18, v171, v7, v18
  v_dot2_f32_bf16 v19, v175, v7, v19
  s_waitcnt vmcnt(4)
  buffer_load_dwordx4 v[72:75], v2, s[32:35], s36 offen offset:2048 nt
  s_waitcnt vmcnt(3)
  v_dot2_f32_bf16 v20, v176, v4, 0
  v_dot2_f32_bf16 v21, v180, v4, 0
  v_dot2_f32_bf16 v22, v184, v4, 0
  v_dot2_f32_bf16 v23, v188, v4, 0
  v_dot2_f32_bf16 v20, v177, v5, v20
  v_dot2_f32_bf16 v21, v181, v5, v21
  v_dot2_f32_bf16 v22, v185, v5, v22
  v_dot2_f32_bf16 v23, v189, v5, v23
  v_dot2_f32_bf16 v20, v178, v6, v20
  v_dot2_f32_bf16 v21, v182, v6, v21
  v_dot2_f32_bf16 v22, v186, v6, v22
  v_dot2_f32_bf16 v23, v190, v6, v23
  v_dot2_f32_bf16 v20, v179, v7, v20
  v_dot2_f32_bf16 v21, v183, v7, v21
  v_dot2_f32_bf16 v22, v187, v7, v22
  v_dot2_f32_bf16 v23, v191, v7, v23
  s_waitcnt vmcnt(4)
  buffer_load_dwordx4 v[76:79], v2, s[32:35], s36 offen offset:3072 nt
  s_addk_i32 s36, 16384
  v_add_f32_dpp v8, v8, v8 row_ror:8 row_mask:0xf bank_mask:0x3
  v_add_f32_dpp v8, v16, v16 row_ror:8 row_mask:0xf bank_mask:0xc
  v_add_f32_dpp v9, v9, v9 row_ror:8 row_mask:0xf bank_mask:0x3
  v_add_f32_dpp v9, v17, v17 row_ror:8 row_mask:0xf bank_mask:0xc
  v_add_f32_dpp v10, v10, v10 row_ror:8 row_mask:0xf bank_mask:0x3
  v_add_f32_dpp v10, v18, v18 row_ror:8 row_mask:0xf bank_mask:0xc
  v_add_f32_dpp v11, v11, v11 row_ror:8 row_mask:0xf bank_mask:0x3
  v_add_f32_dpp v11, v19, v19 row_ror:8 row_mask:0xf bank_mask:0xc
  v_add_f32_dpp v12, v12, v12 row_ror:8 row_mask:0xf bank_mask:0x3
  v_add_f32_dpp v12, v20, v20 row_ror:8 row_mask:0xf bank_mask:0xc
  v_add_f32_dpp v13, v13, v13 row_ror:8 row_mask:0xf bank_mask:0x3
  v_add_f32_dpp v13, v21, v21 row_ror:8 row_mask:0xf bank_mask:0xc
  v_add_f32_dpp v14, v14, v14 row_ror:8 row_mask:0xf bank_mask:0x3
  v_add_f32_dpp v14, v22, v22 row_ror:8 row_mask:0xf bank_mask:0xc
  v_add_f32_dpp v15, v15, v15 row_ror:8 row_mask:0xf bank_mask:0x3
  v_add_f32_dpp v15, v23, v23 row_ror:8 row_mask:0xf bank_mask:0xc
  v_add_f32_dpp v8, v8, v8 row_shl:4 row_mask:0xf bank_mask:0x5
  v_add_f32_dpp v8, v12, v12 row_shr:4 row_mask:0xf bank_mask:0xa
  v_add_f32_dpp v9, v9, v9 row_shl:4 row_mask:0xf bank_mask:0x5
  v_add_f32_dpp v9, v13, v13 row_shr:4 row_mask:0xf bank_mask:0xa
  v_add_f32_dpp v10, v10, v10 row_shl:4 row_mask:0xf bank_mask:0x5
  v_add_f32_dpp v10, v14, v14 row_shr:4 row_mask:0xf bank_mask:0xa
  v_add_f32_dpp v11, v11, v11 row_shl:4 row_mask:0xf bank_mask:0x5
  v_add_f32_dpp v11, v15, v15 row_shr:4 row_mask:0xf bank_mask:0xa
  s_waitcnt vmcnt(4)
  buffer_load_dwordx4 v[80:83], v2, s[32:35], s36 offen nt
  v_add_f32_dpp v8, v8, v8 quad_perm:[2,3,0,1] row_mask:0xf bank_mask:0xf
  v_add_f32_dpp v9, v9, v9 quad_perm:[2,3,0,1] row_mask:0xf bank_mask:0xf
  v_add_f32_dpp v10, v10, v10 quad_perm:[2,3,0,1] row_mask:0xf bank_mask:0xf
  v_add_f32_dpp v11, v11, v11 quad_perm:[2,3,0,1] row_mask:0xf bank_mask:0xf
  v_cndmask_b32 v8, v8, v10, s[46:47]
  v_cndmask_b32 v9, v9, v11, s[46:47]
  s_nop 0
  v_add_f32_dpp v8, v8, v8 quad_perm:[1,0,3,2] row_mask:0xf bank_mask:0xf
  v_add_f32_dpp v9, v9, v9 quad_perm:[1,0,3,2] row_mask:0xf bank_mask:0xf
  v_cndmask_b32 v8, v8, v9, s[48:49]
  v_cvt_pk_bf16_f32 v8, v8, v8
  v_and_b32 v8, s38, v8
  v_mul_f32 v8, s62, v8
  v_cvt_pk_bf16_f32 v8, v8, v8
  v_and_b32 v8, s38, v8
  ds_write_b32 v52, v8
  v_max_f32 v48, v48, v8
  v_add_u32 v52, 256, v52
  s_waitcnt vmcnt(4)
  buffer_load_dwordx4 v[84:87], v2, s[32:35], s36 offen offset:1024 nt
  s_waitcnt vmcnt(5)
  s_mov_b32 s37, 9
L_kloop:
  v_dot2_f32_bf16 v8, v64, v4, 0
  v_dot2_f32_bf16 v8, v65, v5, v8
  v_dot2_f32_bf16 v8, v66, v6, v8
  v_dot2_f32_bf16 v8, v67, v7, v8
  s_waitcnt vmcnt(4)
  buffer_load_dwordx4 v[88:91], v2, s[32:35], s36 offen offset:2048 nt
  v_dot2_f32_bf16 v9, v68, v4, 0
  v_dot2_f32_bf16 v9, v69, v5, v9
  v_dot2_f32_bf16 v9, v70, v6, v9
  v_dot2_f32_bf16 v9, v71, v7, v9
  s_waitcnt vmcnt(4)
  buffer_load_dwordx4 v[92:95], v2, s[32:35], s36 offen offset:3072 nt
  s_addk_i32 s36, 16384
  v_dot2_f32_bf16 v10, v72, v4, 0
  v_dot2_f32_bf16 v10, v73, v5, v10
  v_dot2_f32_bf16 v10, v74, v6, v10
  v_dot2_f32_bf16 v10, v75, v7, v10
  s_waitcnt vmcnt(4)
  buffer_load_dwordx4 v[96:99], v2, s[32:35], s36 offen nt
  v_dot2_f32_bf16 v11, v76, v4, 0
  v_dot2_f32_bf16 v11, v77, v5, v11
  v_dot2_f32_bf16 v11, v78, v6, v11
  v_dot2_f32_bf16 v11, v79, v7, v11
  s_waitcnt vmcnt(4)
  buffer_load_dwordx4 v[100:103], v2, s[32:35], s36 offen offset:1024 nt
  v_dot2_f32_bf16 v12, v80, v4, 0
  v_dot2_f32_bf16 v12, v81, v5, v12
  v_dot2_f32_bf16 v12, v82, v6, v12
  v_dot2_f32_bf16 v12, v83, v7, v12
  s_waitcnt vmcnt(4)
  buffer_load_dwordx4 v[104:107], v2, s[32:35], s36 offen offset:2048 nt
  v_dot2_f32_bf16 v13, v84, v4, 0
  v_dot2_f32_bf16 v13, v85, v5, v13
  v_dot2_f32_bf16 v13, v86, v6, v13
  v_dot2_f32_bf16 v13, v87, v7, v13
  s_waitcnt vmcnt(4)
  buffer_load_dwordx4 v[108:111], v2, s[32:35], s36 offen offset:3072 nt
  s_addk_i32 s36, 16384
  v_dot2_f32_bf16 v14, v88, v4, 0
  v_dot2_f32_bf16 v14, v89, v5, v14
  v_dot2_f32_bf16 v14, v90, v6, v14
  v_dot2_f32_bf16 v14, v91, v7, v14
  s_waitcnt vmcnt(4)
  buffer_load_dwordx4 v[112:115], v2, s[32:35], s36 offen nt
  v_dot2_f32_bf16 v15, v92, v4, 0
  v_dot2_f32_bf16 v15, v93, v5, v15
  v_dot2_f32_bf16 v15, v94, v6, v15
  v_dot2_f32_bf16 v15, v95, v7, v15
  s_waitcnt vmcnt(4)
  buffer_load_dwordx4 v[116:119], v2, s[32:35], s36 offen offset:1024 nt
  v_dot2_f32_bf16 v16, v96, v4, 0
  v_dot2_f32_bf16 v16, v97, v5, v16
  v_dot2_f32_bf16 v16, v98, v6, v16
  v_dot2_f32_bf16 v16, v99, v7, v16
  s_waitcnt vmcnt(4)
  buffer_load_dwordx4 v[120:123], v2, s[32:35], s36 offen offset:2048 nt
  v_dot2_f32_bf16 v17, v100, v4, 0
  v_dot2_f32_bf16 v17, v101, v5, v17
  v_dot2_f32_bf16 v17, v102, v6, v17
  v_dot2_f32_bf16 v17, v103, v7, v17
  s_waitcnt vmcnt(4)
  buffer_load_dwordx4 v[124:127], v2, s[32:35], s36 offen offset:3072 nt
  s_addk_i32 s36, 16384
  v_dot2_f32_bf16 v18, v104, v4, 0
  v_dot2_f32_bf16 v18, v105, v5, v18
  v_dot2_f32_bf16 v18, v106, v6, v18
  v_dot2_f32_bf16 v18, v107, v7, v18
  s_waitcnt vmcnt(4)
  s_cmp_eq_u32 s36, 0x100000
  s_cselect_b32 s32, s60, s32
  s_cselect_b32 s33, s61, s33
  s_cselect_b32 s36, 0, s36
  buffer_load_dwordx4 v[64:67], v2, s[32:35], s36 offen nt
  v_dot2_f32_bf16 v19, v108, v4, 0
  v_dot2_f32_bf16 v19, v109, v5, v19
  v_dot2_f32_bf16 v19, v110, v6, v19
  v_dot2_f32_bf16 v19, v111, v7, v19
  s_waitcnt vmcnt(4)
  buffer_load_dwordx4 v[68:71], v2, s[32:35], s36 offen offset:1024 nt
  v_dot2_f32_bf16 v20, v112, v4, 0
  v_dot2_f32_bf16 v20, v113, v5, v20
  v_dot2_f32_bf16 v20, v114, v6, v20
  v_dot2_f32_bf16 v20, v115, v7, v20
  s_waitcnt vmcnt(4)
  buffer_load_dwordx4 v[72:75], v2, s[32:35], s36 offen offset:2048 nt
  v_dot2_f32_bf16 v21, v116, v4, 0
  v_dot2_f32_bf16 v21, v117, v5, v21
  v_dot2_f32_bf16 v21, v118, v6, v21
  v_dot2_f32_bf16 v21, v119, v7, v21
  s_waitcnt vmcnt(4)
  buffer_load_dwordx4 v[76:79], v2, s[32:35], s36 offen offset:3072 nt
  s_addk_i32 s36, 16384
  v_dot2_f32_bf16 v22, v120, v4, 0
  v_dot2_f32_bf16 v22, v121, v5, v22
  v_dot2_f32_bf16 v22, v122, v6, v22
  v_dot2_f32_bf16 v22, v123, v7, v22
  s_waitcnt vmcnt(4)
  buffer_load_dwordx4 v[80:83], v2, s[32:35], s36 offen nt
  v_dot2_f32_bf16 v23, v124, v4, 0
  v_dot2_f32_bf16 v23, v125, v5, v23
  v_dot2_f32_bf16 v23, v126, v6, v23
  v_dot2_f32_bf16 v23, v127, v7, v23
  v_add_f32_dpp v8, v8, v8 row_ror:8 row_mask:0xf bank_mask:0x3
  v_add_f32_dpp v8, v16, v16 row_ror:8 row_mask:0xf bank_mask:0xc
  v_add_f32_dpp v9, v9, v9 row_ror:8 row_mask:0xf bank_mask:0x3
  v_add_f32_dpp v9, v17, v17 row_ror:8 row_mask:0xf bank_mask:0xc
  v_add_f32_dpp v10, v10, v10 row_ror:8 row_mask:0xf bank_mask:0x3
  v_add_f32_dpp v10, v18, v18 row_ror:8 row_mask:0xf bank_mask:0xc
  v_add_f32_dpp v11, v11, v11 row_ror:8 row_mask:0xf bank_mask:0x3
  v_add_f32_dpp v11, v19, v19 row_ror:8 row_mask:0xf bank_mask:0xc
  v_add_f32_dpp v12, v12, v12 row_ror:8 row_mask:0xf bank_mask:0x3
  v_add_f32_dpp v12, v20, v20 row_ror:8 row_mask:0xf bank_mask:0xc
  v_add_f32_dpp v13, v13, v13 row_ror:8 row_mask:0xf bank_mask:0x3
  v_add_f32_dpp v13, v21, v21 row_ror:8 row_mask:0xf bank_mask:0xc
  v_add_f32_dpp v14, v14, v14 row_ror:8 row_mask:0xf bank_mask:0x3
  v_add_f32_dpp v14, v22, v22 row_ror:8 row_mask:0xf bank_mask:0xc
  v_add_f32_dpp v15, v15, v15 row_ror:8 row_mask:0xf bank_mask:0x3
  v_add_f32_dpp v15, v23, v23 row_ror:8 row_mask:0xf bank_mask:0xc
  v_add_f32_dpp v8, v8, v8 row_shl:4 row_mask:0xf bank_mask:0x5
  v_add_f32_dpp v8, v12, v12 row_shr:4 row_mask:0xf bank_mask:0xa
  v_add_f32_dpp v9, v9, v9 row_shl:4 row_mask:0xf bank_mask:0x5
  v_add_f32_dpp v9, v13, v13 row_shr:4 row_mask:0xf bank_mask:0xa
  v_add_f32_dpp v10, v10, v10 row_shl:4 row_mask:0xf bank_mask:0x5
  v_add_f32_dpp v10, v14, v14 row_shr:4 row_mask:0xf bank_mask:0xa
  v_add_f32_dpp v11, v11, v11 row_shl:4 row_mask:0xf bank_mask:0x5
  v_add_f32_dpp v11, v15, v15 row_shr:4 row_mask:0xf bank_mask:0xa
  s_waitcnt vmcnt(4)
  buffer_load_dwordx4 v[84:87], v2, s[32:35], s36 offen offset:1024 nt
  v_add_f32_dpp v8, v8, v8 quad_perm:[2,3,0,1] row_mask:0xf bank_mask:0xf
  v_add_f32_dpp v9, v9, v9 quad_perm:[2,3,0,1] row_mask:0xf bank_mask:0xf
  v_add_f32_dpp v10, v10, v10 quad_perm:[2,3,0,1] row_mask:0xf bank_mask:0xf
  v_add_f32_dpp v11, v11, v11 quad_perm:[2,3,0,1] row_mask:0xf bank_mask:0xf
  v_cndmask_b32 v8, v8, v10, s[46:47]
  v_cndmask_b32 v9, v9, v11, s[46:47]
  s_nop 0
  v_add_f32_dpp v8, v8, v8 quad_perm:[1,0,3,2] row_mask:0xf bank_mask:0xf
  v_add_f32_dpp v9, v9, v9 quad_perm:[1,0,3,2] row_mask:0xf bank_mask:0xf
  v_cndmask_b32 v8, v8, v9, s[48:49]
  v_cvt_pk_bf16_f32 v8, v8, v8
  v_and_b32 v8, s38, v8
  v_mul_f32 v8, s62, v8
  v_cvt_pk_bf16_f32 v8, v8, v8
  v_and_b32 v8, s38, v8
  ds_write_b32 v52, v8
  v_max_f32 v48, v48, v8
  v_add_u32 v52, 256, v52
  s_sub_u32 s37, s37, 1
  s_cmp_lg_u32 s37, 0
  s_cbranch_scc1 L_kloop
  v_subrev_u32 v52, 4096, v52
  s_waitcnt lgkmcnt(0)
  ds_read_b32 v51, v52
  v_max_f32_dpp v48, v48, v48 row_ror:8 row_mask:0xf bank_mask:0xf
  s_nop 1
  v_max_f32_dpp v48, v48, v48 row_ror:4 row_mask:0xf bank_mask:0xf
  s_nop 1
  v_max_f32_dpp v48, v48, v48 row_ror:2 row_mask:0xf bank_mask:0xf
  s_nop 1
  v_max_f32_dpp v48, v48, v48 row_ror:1 row_mask:0xf bank_mask:0xf
  v_mov_b32 v24, v48
  s_nop 1
  v_permlane16_swap_b32 v48, v24
  v_max_f32 v48, v48, v24
  v_mov_b32 v24, v48
  s_nop 1
  v_permlane32_swap_b32 v48, v24
  v_max_f32 v48, v48, v24
  v_mov_b32 v40, 0
  v_mov_b32 v41, 0
  v_mov_b32 v42, 0
  v_mov_b32 v43, 0
  v_mov_b32 v44, 0
  v_mov_b32 v45, 0
  v_mov_b32 v46, 0
  v_mov_b32 v47, 0
  v_mov_b32 v49, 0
  s_mov_b32 s37, 15
L_vloop:
  s_waitcnt lgkmcnt(0)
  v_sub_f32 v50, v51, v48
  v_add_u32 v52, 256, v52
  v_mul_f32 v50, s63, v50
  ds_read_b32 v51, v52
  v_exp_f32 v50, v50
  s_nop 0
  v_add_f32 v49, v49, v50
  v_lshlrev_b32 v24, 16, v64
  v_and_b32 v25, s38, v64
  v_lshlrev_b32 v26, 16, v65
  v_and_b32 v27, s38, v65
  v_lshlrev_b32 v28, 16, v66
  v_and_b32 v29, s38, v66
  v_lshlrev_b32 v30, 16, v67
  v_and_b32 v31, s38, v67
  v_fmac_f32_dpp v40, v50, v24 row_newbcast:0 row_mask:0xf bank_mask:0xf
  v_fmac_f32_dpp v41, v50, v25 row_newbcast:0 row_mask:0xf bank_mask:0xf
  v_fmac_f32_dpp v42, v50, v26 row_newbcast:0 row_mask:0xf bank_mask:0xf
  v_fmac_f32_dpp v43, v50, v27 row_newbcast:0 row_mask:0xf bank_mask:0xf
  v_fmac_f32_dpp v44, v50, v28 row_newbcast:0 row_mask:0xf bank_mask:0xf
  v_fmac_f32_dpp v45, v50, v29 row_newbcast:0 row_mask:0xf bank_mask:0xf
  v_fmac_f32_dpp v46, v50, v30 row_newbcast:0 row_mask:0xf bank_mask:0xf
  v_fmac_f32_dpp v47, v50, v31 row_newbcast:0 row_mask:0xf bank_mask:0xf
  s_waitcnt vmcnt(4)
  buffer_load_dwordx4 v[88:91], v2, s[32:35], s36 offen offset:2048 nt
  v_lshlrev_b32 v24, 16, v68
  v_and_b32 v25, s38, v68
  v_lshlrev_b32 v26, 16, v69
  v_and_b32 v27, s38, v69
  v_lshlrev_b32 v28, 16, v70
  v_and_b32 v29, s38, v70
  v_lshlrev_b32 v30, 16, v71
  v_and_b32 v31, s38, v71
  v_fmac_f32_dpp v40, v50, v24 row_newbcast:1 row_mask:0xf bank_mask:0xf
  v_fmac_f32_dpp v41, v50, v25 row_newbcast:1 row_mask:0xf bank_mask:0xf
  v_fmac_f32_dpp v42, v50, v26 row_newbcast:1 row_mask:0xf bank_mask:0xf
  v_fmac_f32_dpp v43, v50, v27 row_newbcast:1 row_mask:0xf bank_mask:0xf
  v_fmac_f32_dpp v44, v50, v28 row_newbcast:1 row_mask:0xf bank_mask:0xf
  v_fmac_f32_dpp v45, v50, v29 row_newbcast:1 row_mask:0xf bank_mask:0xf
  v_fmac_f32_dpp v46, v50, v30 row_newbcast:1 row_mask:0xf bank_mask:0xf
  v_fmac_f32_dpp v47, v50, v31 row_newbcast:1 row_mask:0xf bank_mask:0xf
  s_waitcnt vmcnt(4)
  buffer_load_dwordx4 v[92:95], v2, s[32:35], s36 offen offset:3072 nt
  s_addk_i32 s36, 16384
  v_lshlrev_b32 v24, 16, v72
  v_and_b32 v25, s38, v72
  v_lshlrev_b32 v26, 16, v73
  v_and_b32 v27, s38, v73
  v_lshlrev_b32 v28, 16, v74
  v_and_b32 v29, s38, v74
  v_lshlrev_b32 v30, 16, v75
  v_and_b32 v31, s38, v75
  v_fmac_f32_dpp v40, v50, v24 row_newbcast:2 row_mask:0xf bank_mask:0xf
  v_fmac_f32_dpp v41, v50, v25 row_newbcast:2 row_mask:0xf bank_mask:0xf
  v_fmac_f32_dpp v42, v50, v26 row_newbcast:2 row_mask:0xf bank_mask:0xf
  v_fmac_f32_dpp v43, v50, v27 row_newbcast:2 row_mask:0xf bank_mask:0xf
  v_fmac_f32_dpp v44, v50, v28 row_newbcast:2 row_mask:0xf bank_mask:0xf
  v_fmac_f32_dpp v45, v50, v29 row_newbcast:2 row_mask:0xf bank_mask:0xf
  v_fmac_f32_dpp v46, v50, v30 row_newbcast:2 row_mask:0xf bank_mask:0xf
  v_fmac_f32_dpp v47, v50, v31 row_newbcast:2 row_mask:0xf bank_mask:0xf
  s_waitcnt vmcnt(4)
  buffer_load_dwordx4 v[96:99], v2, s[32:35], s36 offen nt
  v_lshlrev_b32 v24, 16, v76
  v_and_b32 v25, s38, v76
  v_lshlrev_b32 v26, 16, v77
  v_and_b32 v27, s38, v77
  v_lshlrev_b32 v28, 16, v78
  v_and_b32 v29, s38, v78
  v_lshlrev_b32 v30, 16, v79
  v_and_b32 v31, s38, v79
  v_fmac_f32_dpp v40, v50, v24 row_newbcast:3 row_mask:0xf bank_mask:0xf
  v_fmac_f32_dpp v41, v50, v25 row_newbcast:3 row_mask:0xf bank_mask:0xf
  v_fmac_f32_dpp v42, v50, v26 row_newbcast:3 row_mask:0xf bank_mask:0xf
  v_fmac_f32_dpp v43, v50, v27 row_newbcast:3 row_mask:0xf bank_mask:0xf
  v_fmac_f32_dpp v44, v50, v28 row_newbcast:3 row_mask:0xf bank_mask:0xf
  v_fmac_f32_dpp v45, v50, v29 row_newbcast:3 row_mask:0xf bank_mask:0xf
  v_fmac_f32_dpp v46, v50, v30 row_newbcast:3 row_mask:0xf bank_mask:0xf
  v_fmac_f32_dpp v47, v50, v31 row_newbcast:3 row_mask:0xf bank_mask:0xf
  s_waitcnt vmcnt(4)
  buffer_load_dwordx4 v[100:103], v2, s[32:35], s36 offen offset:1024 nt
  v_lshlrev_b32 v24, 16, v80
  v_and_b32 v25, s38, v80
  v_lshlrev_b32 v26, 16, v81
  v_and_b32 v27, s38, v81
  v_lshlrev_b32 v28, 16, v82
  v_and_b32 v29, s38, v82
  v_lshlrev_b32 v30, 16, v83
  v_and_b32 v31, s38, v83
  v_fmac_f32_dpp v40, v50, v24 row_newbcast:4 row_mask:0xf bank_mask:0xf
  v_fmac_f32_dpp v41, v50, v25 row_newbcast:4 row_mask:0xf bank_mask:0xf
  v_fmac_f32_dpp v42, v50, v26 row_newbcast:4 row_mask:0xf bank_mask:0xf
  v_fmac_f32_dpp v43, v50, v27 row_newbcast:4 row_mask:0xf bank_mask:0xf
  v_fmac_f32_dpp v44, v50, v28 row_newbcast:4 row_mask:0xf bank_mask:0xf
  v_fmac_f32_dpp v45, v50, v29 row_newbcast:4 row_mask:0xf bank_mask:0xf
  v_fmac_f32_dpp v46, v50, v30 row_newbcast:4 row_mask:0xf bank_mask:0xf
  v_fmac_f32_dpp v47, v50, v31 row_newbcast:4 row_mask:0xf bank_mask:0xf
  s_waitcnt vmcnt(4)
  buffer_load_dwordx4 v[104:107], v2, s[32:35], s36 offen offset:2048 nt
  v_lshlrev_b32 v24, 16, v84
  v_and_b32 v25, s38, v84
  v_lshlrev_b32 v26, 16, v85
  v_and_b32 v27, s38, v85
  v_lshlrev_b32 v28, 16, v86
  v_and_b32 v29, s38, v86
  v_lshlrev_b32 v30, 16, v87
  v_and_b32 v31, s38, v87
  v_fmac_f32_dpp v40, v50, v24 row_newbcast:5 row_mask:0xf bank_mask:0xf
  v_fmac_f32_dpp v41, v50, v25 row_newbcast:5 row_mask:0xf bank_mask:0xf
  v_fmac_f32_dpp v42, v50, v26 row_newbcast:5 row_mask:0xf bank_mask:0xf
  v_fmac_f32_dpp v43, v50, v27 row_newbcast:5 row_mask:0xf bank_mask:0xf
  v_fmac_f32_dpp v44, v50, v28 row_newbcast:5 row_mask:0xf bank_mask:0xf
  v_fmac_f32_dpp v45, v50, v29 row_newbcast:5 row_mask:0xf bank_mask:0xf
  v_fmac_f32_dpp v46, v50, v30 row_newbcast:5 row_mask:0xf bank_mask:0xf
  v_fmac_f32_dpp v47, v50, v31 row_newbcast:5 row_mask:0xf bank_mask:0xf
  s_waitcnt vmcnt(4)
  buffer_load_dwordx4 v[108:111], v2, s[32:35], s36 offen offset:3072 nt
  s_addk_i32 s36, 16384
  v_lshlrev_b32 v24, 16, v88
  v_and_b32 v25, s38, v88
  v_lshlrev_b32 v26, 16, v89
  v_and_b32 v27, s38, v89
  v_lshlrev_b32 v28, 16, v90
  v_and_b32 v29, s38, v90
  v_lshlrev_b32 v30, 16, v91
  v_and_b32 v31, s38, v91
  v_fmac_f32_dpp v40, v50, v24 row_newbcast:6 row_mask:0xf bank_mask:0xf
  v_fmac_f32_dpp v41, v50, v25 row_newbcast:6 row_mask:0xf bank_mask:0xf
  v_fmac_f32_dpp v42, v50, v26 row_newbcast:6 row_mask:0xf bank_mask:0xf
  v_fmac_f32_dpp v43, v50, v27 row_newbcast:6 row_mask:0xf bank_mask:0xf
  v_fmac_f32_dpp v44, v50, v28 row_newbcast:6 row_mask:0xf bank_mask:0xf
  v_fmac_f32_dpp v45, v50, v29 row_newbcast:6 row_mask:0xf bank_mask:0xf
  v_fmac_f32_dpp v46, v50, v30 row_newbcast:6 row_mask:0xf bank_mask:0xf
  v_fmac_f32_dpp v47, v50, v31 row_newbcast:6 row_mask:0xf bank_mask:0xf
  s_waitcnt vmcnt(4)
  buffer_load_dwordx4 v[112:115], v2, s[32:35], s36 offen nt
  v_lshlrev_b32 v24, 16, v92
  v_and_b32 v25, s38, v92
  v_lshlrev_b32 v26, 16, v93
  v_and_b32 v27, s38, v93
  v_lshlrev_b32 v28, 16, v94
  v_and_b32 v29, s38, v94
  v_lshlrev_b32 v30, 16, v95
  v_and_b32 v31, s38, v95
  v_fmac_f32_dpp v40, v50, v24 row_newbcast:7 row_mask:0xf bank_mask:0xf
  v_fmac_f32_dpp v41, v50, v25 row_newbcast:7 row_mask:0xf bank_mask:0xf
  v_fmac_f32_dpp v42, v50, v26 row_newbcast:7 row_mask:0xf bank_mask:0xf
  v_fmac_f32_dpp v43, v50, v27 row_newbcast:7 row_mask:0xf bank_mask:0xf
  v_fmac_f32_dpp v44, v50, v28 row_newbcast:7 row_mask:0xf bank_mask:0xf
  v_fmac_f32_dpp v45, v50, v29 row_newbcast:7 row_mask:0xf bank_mask:0xf
  v_fmac_f32_dpp v46, v50, v30 row_newbcast:7 row_mask:0xf bank_mask:0xf
  v_fmac_f32_dpp v47, v50, v31 row_newbcast:7 row_mask:0xf bank_mask:0xf
  s_waitcnt vmcnt(4)
  buffer_load_dwordx4 v[116:119], v2, s[32:35], s36 offen offset:1024 nt
  v_lshlrev_b32 v24, 16, v96
  v_and_b32 v25, s38, v96
  v_lshlrev_b32 v26, 16, v97
  v_and_b32 v27, s38, v97
  v_lshlrev_b32 v28, 16, v98
  v_and_b32 v29, s38, v98
  v_lshlrev_b32 v30, 16, v99
  v_and_b32 v31, s38, v99
  v_fmac_f32_dpp v40, v50, v24 row_newbcast:8 row_mask:0xf bank_mask:0xf
  v_fmac_f32_dpp v41, v50, v25 row_newbcast:8 row_mask:0xf bank_mask:0xf
  v_fmac_f32_dpp v42, v50, v26 row_newbcast:8 row_mask:0xf bank_mask:0xf
  v_fmac_f32_dpp v43, v50, v27 row_newbcast:8 row_mask:0xf bank_mask:0xf
  v_fmac_f32_dpp v44, v50, v28 row_newbcast:8 row_mask:0xf bank_mask:0xf
  v_fmac_f32_dpp v45, v50, v29 row_newbcast:8 row_mask:0xf bank_mask:0xf
  v_fmac_f32_dpp v46, v50, v30 row_newbcast:8 row_mask:0xf bank_mask:0xf
  v_fmac_f32_dpp v47, v50, v31 row_newbcast:8 row_mask:0xf bank_mask:0xf
  s_waitcnt vmcnt(4)
  buffer_load_dwordx4 v[120:123], v2, s[32:35], s36 offen offset:2048 nt
  v_lshlrev_b32 v24, 16, v100
  v_and_b32 v25, s38, v100
  v_lshlrev_b32 v26, 16, v101
  v_and_b32 v27, s38, v101
  v_lshlrev_b32 v28, 16, v102
  v_and_b32 v29, s38, v102
  v_lshlrev_b32 v30, 16, v103
  v_and_b32 v31, s38, v103
  v_fmac_f32_dpp v40, v50, v24 row_newbcast:9 row_mask:0xf bank_mask:0xf
  v_fmac_f32_dpp v41, v50, v25 row_newbcast:9 row_mask:0xf bank_mask:0xf
  v_fmac_f32_dpp v42, v50, v26 row_newbcast:9 row_mask:0xf bank_mask:0xf
  v_fmac_f32_dpp v43, v50, v27 row_newbcast:9 row_mask:0xf bank_mask:0xf
  v_fmac_f32_dpp v44, v50, v28 row_newbcast:9 row_mask:0xf bank_mask:0xf
  v_fmac_f32_dpp v45, v50, v29 row_newbcast:9 row_mask:0xf bank_mask:0xf
  v_fmac_f32_dpp v46, v50, v30 row_newbcast:9 row_mask:0xf bank_mask:0xf
  v_fmac_f32_dpp v47, v50, v31 row_newbcast:9 row_mask:0xf bank_mask:0xf
  s_waitcnt vmcnt(4)
  buffer_load_dwordx4 v[124:127], v2, s[32:35], s36 offen offset:3072 nt
  s_addk_i32 s36, 16384
  v_lshlrev_b32 v24, 16, v104
  v_and_b32 v25, s38, v104
  v_lshlrev_b32 v26, 16, v105
  v_and_b32 v27, s38, v105
  v_lshlrev_b32 v28, 16, v106
  v_and_b32 v29, s38, v106
  v_lshlrev_b32 v30, 16, v107
  v_and_b32 v31, s38, v107
  v_fmac_f32_dpp v40, v50, v24 row_newbcast:10 row_mask:0xf bank_mask:0xf
  v_fmac_f32_dpp v41, v50, v25 row_newbcast:10 row_mask:0xf bank_mask:0xf
  v_fmac_f32_dpp v42, v50, v26 row_newbcast:10 row_mask:0xf bank_mask:0xf
  v_fmac_f32_dpp v43, v50, v27 row_newbcast:10 row_mask:0xf bank_mask:0xf
  v_fmac_f32_dpp v44, v50, v28 row_newbcast:10 row_mask:0xf bank_mask:0xf
  v_fmac_f32_dpp v45, v50, v29 row_newbcast:10 row_mask:0xf bank_mask:0xf
  v_fmac_f32_dpp v46, v50, v30 row_newbcast:10 row_mask:0xf bank_mask:0xf
  v_fmac_f32_dpp v47, v50, v31 row_newbcast:10 row_mask:0xf bank_mask:0xf
  s_waitcnt vmcnt(4)
  buffer_load_dwordx4 v[64:67], v2, s[32:35], s36 offen nt
  v_lshlrev_b32 v24, 16, v108
  v_and_b32 v25, s38, v108
  v_lshlrev_b32 v26, 16, v109
  v_and_b32 v27, s38, v109
  v_lshlrev_b32 v28, 16, v110
  v_and_b32 v29, s38, v110
  v_lshlrev_b32 v30, 16, v111
  v_and_b32 v31, s38, v111
  v_fmac_f32_dpp v40, v50, v24 row_newbcast:11 row_mask:0xf bank_mask:0xf
  v_fmac_f32_dpp v41, v50, v25 row_newbcast:11 row_mask:0xf bank_mask:0xf
  v_fmac_f32_dpp v42, v50, v26 row_newbcast:11 row_mask:0xf bank_mask:0xf
  v_fmac_f32_dpp v43, v50, v27 row_newbcast:11 row_mask:0xf bank_mask:0xf
  v_fmac_f32_dpp v44, v50, v28 row_newbcast:11 row_mask:0xf bank_mask:0xf
  v_fmac_f32_dpp v45, v50, v29 row_newbcast:11 row_mask:0xf bank_mask:0xf
  v_fmac_f32_dpp v46, v50, v30 row_newbcast:11 row_mask:0xf bank_mask:0xf
  v_fmac_f32_dpp v47, v50, v31 row_newbcast:11 row_mask:0xf bank_mask:0xf
  s_waitcnt vmcnt(4)
  buffer_load_dwordx4 v[68:71], v2, s[32:35], s36 offen offset:1024 nt
  v_lshlrev_b32 v24, 16, v112
  v_and_b32 v25, s38, v112
  v_lshlrev_b32 v26, 16, v113
  v_and_b32 v27, s38, v113
  v_lshlrev_b32 v28, 16, v114
  v_and_b32 v29, s38, v114
  v_lshlrev_b32 v30, 16, v115
  v_and_b32 v31, s38, v115
  v_fmac_f32_dpp v40, v50, v24 row_newbcast:12 row_mask:0xf bank_mask:0xf
  v_fmac_f32_dpp v41, v50, v25 row_newbcast:12 row_mask:0xf bank_mask:0xf
  v_fmac_f32_dpp v42, v50, v26 row_newbcast:12 row_mask:0xf bank_mask:0xf
  v_fmac_f32_dpp v43, v50, v27 row_newbcast:12 row_mask:0xf bank_mask:0xf
  v_fmac_f32_dpp v44, v50, v28 row_newbcast:12 row_mask:0xf bank_mask:0xf
  v_fmac_f32_dpp v45, v50, v29 row_newbcast:12 row_mask:0xf bank_mask:0xf
  v_fmac_f32_dpp v46, v50, v30 row_newbcast:12 row_mask:0xf bank_mask:0xf
  v_fmac_f32_dpp v47, v50, v31 row_newbcast:12 row_mask:0xf bank_mask:0xf
  s_waitcnt vmcnt(4)
  buffer_load_dwordx4 v[72:75], v2, s[32:35], s36 offen offset:2048 nt
  v_lshlrev_b32 v24, 16, v116
  v_and_b32 v25, s38, v116
  v_lshlrev_b32 v26, 16, v117
  v_and_b32 v27, s38, v117
  v_lshlrev_b32 v28, 16, v118
  v_and_b32 v29, s38, v118
  v_lshlrev_b32 v30, 16, v119
  v_and_b32 v31, s38, v119
  v_fmac_f32_dpp v40, v50, v24 row_newbcast:13 row_mask:0xf bank_mask:0xf
  v_fmac_f32_dpp v41, v50, v25 row_newbcast:13 row_mask:0xf bank_mask:0xf
  v_fmac_f32_dpp v42, v50, v26 row_newbcast:13 row_mask:0xf bank_mask:0xf
  v_fmac_f32_dpp v43, v50, v27 row_newbcast:13 row_mask:0xf bank_mask:0xf
  v_fmac_f32_dpp v44, v50, v28 row_newbcast:13 row_mask:0xf bank_mask:0xf
  v_fmac_f32_dpp v45, v50, v29 row_newbcast:13 row_mask:0xf bank_mask:0xf
  v_fmac_f32_dpp v46, v50, v30 row_newbcast:13 row_mask:0xf bank_mask:0xf
  v_fmac_f32_dpp v47, v50, v31 row_newbcast:13 row_mask:0xf bank_mask:0xf
  s_waitcnt vmcnt(4)
  buffer_load_dwordx4 v[76:79], v2, s[32:35], s36 offen offset:3072 nt
  s_addk_i32 s36, 16384
  v_lshlrev_b32 v24, 16, v120
  v_and_b32 v25, s38, v120
  v_lshlrev_b32 v26, 16, v121
  v_and_b32 v27, s38, v121
  v_lshlrev_b32 v28, 16, v122
  v_and_b32 v29, s38, v122
  v_lshlrev_b32 v30, 16, v123
  v_and_b32 v31, s38, v123
  v_fmac_f32_dpp v40, v50, v24 row_newbcast:14 row_mask:0xf bank_mask:0xf
  v_fmac_f32_dpp v41, v50, v25 row_newbcast:14 row_mask:0xf bank_mask:0xf
  v_fmac_f32_dpp v42, v50, v26 row_newbcast:14 row_mask:0xf bank_mask:0xf
  v_fmac_f32_dpp v43, v50, v27 row_newbcast:14 row_mask:0xf bank_mask:0xf
  v_fmac_f32_dpp v44, v50, v28 row_newbcast:14 row_mask:0xf bank_mask:0xf
  v_fmac_f32_dpp v45, v50, v29 row_newbcast:14 row_mask:0xf bank_mask:0xf
  v_fmac_f32_dpp v46, v50, v30 row_newbcast:14 row_mask:0xf bank_mask:0xf
  v_fmac_f32_dpp v47, v50, v31 row_newbcast:14 row_mask:0xf bank_mask:0xf
  s_waitcnt vmcnt(4)
  buffer_load_dwordx4 v[80:83], v2, s[32:35], s36 offen nt
  v_lshlrev_b32 v24, 16, v124
  v_and_b32 v25, s38, v124
  v_lshlrev_b32 v26, 16, v125
  v_and_b32 v27, s38, v125
  v_lshlrev_b32 v28, 16, v126
  v_and_b32 v29, s38, v126
  v_lshlrev_b32 v30, 16, v127
  v_and_b32 v31, s38, v127
  v_fmac_f32_dpp v40, v50, v24 row_newbcast:15 row_mask:0xf bank_mask:0xf
  v_fmac_f32_dpp v41, v50, v25 row_newbcast:15 row_mask:0xf bank_mask:0xf
  v_fmac_f32_dpp v42, v50, v26 row_newbcast:15 row_mask:0xf bank_mask:0xf
  v_fmac_f32_dpp v43, v50, v27 row_newbcast:15 row_mask:0xf bank_mask:0xf
  v_fmac_f32_dpp v44, v50, v28 row_newbcast:15 row_mask:0xf bank_mask:0xf
  v_fmac_f32_dpp v45, v50, v29 row_newbcast:15 row_mask:0xf bank_mask:0xf
  v_fmac_f32_dpp v46, v50, v30 row_newbcast:15 row_mask:0xf bank_mask:0xf
  v_fmac_f32_dpp v47, v50, v31 row_newbcast:15 row_mask:0xf bank_mask:0xf
  s_waitcnt vmcnt(4)
  buffer_load_dwordx4 v[84:87], v2, s[32:35], s36 offen offset:1024 nt
  s_sub_u32 s37, s37, 1
  s_cmp_lg_u32 s37, 0
  s_cbranch_scc1 L_vloop
  buffer_load_dwordx4 v[88:91], v2, s[32:35], s36 offen offset:2048 nt
  buffer_load_dwordx4 v[92:95], v2, s[32:35], s36 offen offset:3072 nt
  s_addk_i32 s36, 16384
  buffer_load_dwordx4 v[96:99], v2, s[32:35], s36 offen nt
  s_waitcnt lgkmcnt(0)
  v_sub_f32 v50, v51, v48
  v_add_u32 v52, 256, v52
  v_mul_f32 v50, s63, v50
  ds_read_b32 v51, v52
  v_exp_f32 v50, v50
  s_nop 0
  v_add_f32 v49, v49, v50
  s_nop 1
  v_add_f32_dpp v49, v49, v49 row_ror:8 row_mask:0xf bank_mask:0xf
  s_nop 1
  v_add_f32_dpp v49, v49, v49 row_ror:4 row_mask:0xf bank_mask:0xf
  s_nop 1
  v_add_f32_dpp v49, v49, v49 row_ror:2 row_mask:0xf bank_mask:0xf
  s_nop 1
  v_add_f32_dpp v49, v49, v49 row_ror:1 row_mask:0xf bank_mask:0xf
  v_mov_b32 v24, v49
  s_nop 1
  v_permlane16_swap_b32 v49, v24
  v_add_f32 v49, v49, v24
  v_mov_b32 v24, v49
  s_nop 1
  v_permlane32_swap_b32 v49, v24
  v_add_f32 v49, v49, v24
  s_lshl_b32 s50, s30, 3
  v_mov_b32 v26, s50
  v_mov_b32 v28, v48
  v_mov_b32 v29, v49
  v_mov_b32 v30, 0
  v_mov_b32 v31, 1
  s_mov_b64 exec, 1
  ds_write_b64 v26, v[28:29] offset:6656
  s_waitcnt lgkmcnt(0)
  ds_add_u32 v30, v31 offset:6724
  s_mov_b64 exec, -1
  v_lshrrev_b32 v25, 4, v1
  v_lshlrev_b32 v25, 3, v25
  v_add_u32 v3, v3, v25
  s_lshl_b32 s50, s30, 15
  v_add_u32 v3, s50, v3
  v_lshlrev_b32 v24, 16, v64
  v_and_b32 v25, s38, v64
  v_lshlrev_b32 v26, 16, v65
  v_and_b32 v27, s38, v65
  v_lshlrev_b32 v28, 16, v66
  v_and_b32 v29, s38, v66
  v_lshlrev_b32 v30, 16, v67
  v_and_b32 v31, s38, v67
  v_fmac_f32_dpp v40, v50, v24 row_newbcast:0 row_mask:0xf bank_mask:0xf
  v_fmac_f32_dpp v41, v50, v25 row_newbcast:0 row_mask:0xf bank_mask:0xf
  v_fmac_f32_dpp v42, v50, v26 row_newbcast:0 row_mask:0xf bank_mask:0xf
  v_fmac_f32_dpp v43, v50, v27 row_newbcast:0 row_mask:0xf bank_mask:0xf
  v_fmac_f32_dpp v44, v50, v28 row_newbcast:0 row_mask:0xf bank_mask:0xf
  v_fmac_f32_dpp v45, v50, v29 row_newbcast:0 row_mask:0xf bank_mask:0xf
  v_fmac_f32_dpp v46, v50, v30 row_newbcast:0 row_mask:0xf bank_mask:0xf
  v_fmac_f32_dpp v47, v50, v31 row_newbcast:0 row_mask:0xf bank_mask:0xf
  s_waitcnt vmcnt(7)
  buffer_load_dwordx4 v[100:103], v2, s[32:35], s36 offen offset:1024 nt
  v_lshlrev_b32 v24, 16, v68
  v_and_b32 v25, s38, v68
  v_lshlrev_b32 v26, 16, v69
  v_and_b32 v27, s38, v69
  v_lshlrev_b32 v28, 16, v70
  v_and_b32 v29, s38, v70
  v_lshlrev_b32 v30, 16, v71
  v_and_b32 v31, s38, v71
  v_fmac_f32_dpp v40, v50, v24 row_newbcast:1 row_mask:0xf bank_mask:0xf
  v_fmac_f32_dpp v41, v50, v25 row_newbcast:1 row_mask:0xf bank_mask:0xf
  v_fmac_f32_dpp v42, v50, v26 row_newbcast:1 row_mask:0xf bank_mask:0xf
  v_fmac_f32_dpp v43, v50, v27 row_newbcast:1 row_mask:0xf bank_mask:0xf
  v_fmac_f32_dpp v44, v50, v28 row_newbcast:1 row_mask:0xf bank_mask:0xf
  v_fmac_f32_dpp v45, v50, v29 row_newbcast:1 row_mask:0xf bank_mask:0xf
  v_fmac_f32_dpp v46, v50, v30 row_newbcast:1 row_mask:0xf bank_mask:0xf
  v_fmac_f32_dpp v47, v50, v31 row_newbcast:1 row_mask:0xf bank_mask:0xf
  s_waitcnt vmcnt(7)
  buffer_load_dwordx4 v[104:107], v2, s[32:35], s36 offen offset:2048 nt
  v_lshlrev_b32 v24, 16, v72
  v_and_b32 v25, s38, v72
  v_lshlrev_b32 v26, 16, v73
  v_and_b32 v27, s38, v73
  v_lshlrev_b32 v28, 16, v74
  v_and_b32 v29, s38, v74
  v_lshlrev_b32 v30, 16, v75
  v_and_b32 v31, s38, v75
  v_fmac_f32_dpp v40, v50, v24 row_newbcast:2 row_mask:0xf bank_mask:0xf
  v_fmac_f32_dpp v41, v50, v25 row_newbcast:2 row_mask:0xf bank_mask:0xf
  v_fmac_f32_dpp v42, v50, v26 row_newbcast:2 row_mask:0xf bank_mask:0xf
  v_fmac_f32_dpp v43, v50, v27 row_newbcast:2 row_mask:0xf bank_mask:0xf
  v_fmac_f32_dpp v44, v50, v28 row_newbcast:2 row_mask:0xf bank_mask:0xf
  v_fmac_f32_dpp v45, v50, v29 row_newbcast:2 row_mask:0xf bank_mask:0xf
  v_fmac_f32_dpp v46, v50, v30 row_newbcast:2 row_mask:0xf bank_mask:0xf
  v_fmac_f32_dpp v47, v50, v31 row_newbcast:2 row_mask:0xf bank_mask:0xf
  s_waitcnt vmcnt(7)
  buffer_load_dwordx4 v[108:111], v2, s[32:35], s36 offen offset:3072 nt
  s_addk_i32 s36, 16384
  v_lshlrev_b32 v24, 16, v76
  v_and_b32 v25, s38, v76
  v_lshlrev_b32 v26, 16, v77
  v_and_b32 v27, s38, v77
  v_lshlrev_b32 v28, 16, v78
  v_and_b32 v29, s38, v78
  v_lshlrev_b32 v30, 16, v79
  v_and_b32 v31, s38, v79
  v_fmac_f32_dpp v40, v50, v24 row_newbcast:3 row_mask:0xf bank_mask:0xf
  v_fmac_f32_dpp v41, v50, v25 row_newbcast:3 row_mask:0xf bank_mask:0xf
  v_fmac_f32_dpp v42, v50, v26 row_newbcast:3 row_mask:0xf bank_mask:0xf
  v_fmac_f32_dpp v43, v50, v27 row_newbcast:3 row_mask:0xf bank_mask:0xf
  v_fmac_f32_dpp v44, v50, v28 row_newbcast:3 row_mask:0xf bank_mask:0xf
  v_fmac_f32_dpp v45, v50, v29 row_newbcast:3 row_mask:0xf bank_mask:0xf
  v_fmac_f32_dpp v46, v50, v30 row_newbcast:3 row_mask:0xf bank_mask:0xf
  v_fmac_f32_dpp v47, v50, v31 row_newbcast:3 row_mask:0xf bank_mask:0xf
  s_waitcnt vmcnt(7)
  buffer_load_dwordx4 v[112:115], v2, s[32:35], s36 offen nt
  v_lshlrev_b32 v24, 16, v80
  v_and_b32 v25, s38, v80
  v_lshlrev_b32 v26, 16, v81
  v_and_b32 v27, s38, v81
  v_lshlrev_b32 v28, 16, v82
  v_and_b32 v29, s38, v82
  v_lshlrev_b32 v30, 16, v83
  v_and_b32 v31, s38, v83
  v_fmac_f32_dpp v40, v50, v24 row_newbcast:4 row_mask:0xf bank_mask:0xf
  v_fmac_f32_dpp v41, v50, v25 row_newbcast:4 row_mask:0xf bank_mask:0xf
  v_fmac_f32_dpp v42, v50, v26 row_newbcast:4 row_mask:0xf bank_mask:0xf
  v_fmac_f32_dpp v43, v50, v27 row_newbcast:4 row_mask:0xf bank_mask:0xf
  v_fmac_f32_dpp v44, v50, v28 row_newbcast:4 row_mask:0xf bank_mask:0xf
  v_fmac_f32_dpp v45, v50, v29 row_newbcast:4 row_mask:0xf bank_mask:0xf
  v_fmac_f32_dpp v46, v50, v30 row_newbcast:4 row_mask:0xf bank_mask:0xf
  v_fmac_f32_dpp v47, v50, v31 row_newbcast:4 row_mask:0xf bank_mask:0xf
  s_waitcnt vmcnt(7)
  buffer_load_dwordx4 v[116:119], v2, s[32:35], s36 offen offset:1024 nt
  v_lshlrev_b32 v24, 16, v84
  v_and_b32 v25, s38, v84
  v_lshlrev_b32 v26, 16, v85
  v_and_b32 v27, s38, v85
  v_lshlrev_b32 v28, 16, v86
  v_and_b32 v29, s38, v86
  v_lshlrev_b32 v30, 16, v87
  v_and_b32 v31, s38, v87
  v_fmac_f32_dpp v40, v50, v24 row_newbcast:5 row_mask:0xf bank_mask:0xf
  v_fmac_f32_dpp v41, v50, v25 row_newbcast:5 row_mask:0xf bank_mask:0xf
  v_fmac_f32_dpp v42, v50, v26 row_newbcast:5 row_mask:0xf bank_mask:0xf
  v_fmac_f32_dpp v43, v50, v27 row_newbcast:5 row_mask:0xf bank_mask:0xf
  v_fmac_f32_dpp v44, v50, v28 row_newbcast:5 row_mask:0xf bank_mask:0xf
  v_fmac_f32_dpp v45, v50, v29 row_newbcast:5 row_mask:0xf bank_mask:0xf
  v_fmac_f32_dpp v46, v50, v30 row_newbcast:5 row_mask:0xf bank_mask:0xf
  v_fmac_f32_dpp v47, v50, v31 row_newbcast:5 row_mask:0xf bank_mask:0xf
  s_waitcnt vmcnt(7)
  buffer_load_dwordx4 v[120:123], v2, s[32:35], s36 offen offset:2048 nt
  v_lshlrev_b32 v24, 16, v88
  v_and_b32 v25, s38, v88
  v_lshlrev_b32 v26, 16, v89
  v_and_b32 v27, s38, v89
  v_lshlrev_b32 v28, 16, v90
  v_and_b32 v29, s38, v90
  v_lshlrev_b32 v30, 16, v91
  v_and_b32 v31, s38, v91
  v_fmac_f32_dpp v40, v50, v24 row_newbcast:6 row_mask:0xf bank_mask:0xf
  v_fmac_f32_dpp v41, v50, v25 row_newbcast:6 row_mask:0xf bank_mask:0xf
  v_fmac_f32_dpp v42, v50, v26 row_newbcast:6 row_mask:0xf bank_mask:0xf
  v_fmac_f32_dpp v43, v50, v27 row_newbcast:6 row_mask:0xf bank_mask:0xf
  v_fmac_f32_dpp v44, v50, v28 row_newbcast:6 row_mask:0xf bank_mask:0xf
  v_fmac_f32_dpp v45, v50, v29 row_newbcast:6 row_mask:0xf bank_mask:0xf
  v_fmac_f32_dpp v46, v50, v30 row_newbcast:6 row_mask:0xf bank_mask:0xf
  v_fmac_f32_dpp v47, v50, v31 row_newbcast:6 row_mask:0xf bank_mask:0xf
  s_waitcnt vmcnt(7)
  buffer_load_dwordx4 v[124:127], v2, s[32:35], s36 offen offset:3072 nt
  s_addk_i32 s36, 16384
  v_lshlrev_b32 v24, 16, v92
  v_and_b32 v25, s38, v92
  v_lshlrev_b32 v26, 16, v93
  v_and_b32 v27, s38, v93
  v_lshlrev_b32 v28, 16, v94
  v_and_b32 v29, s38, v94
  v_lshlrev_b32 v30, 16, v95
  v_and_b32 v31, s38, v95
  v_fmac_f32_dpp v40, v50, v24 row_newbcast:7 row_mask:0xf bank_mask:0xf
  v_fmac_f32_dpp v41, v50, v25 row_newbcast:7 row_mask:0xf bank_mask:0xf
  v_fmac_f32_dpp v42, v50, v26 row_newbcast:7 row_mask:0xf bank_mask:0xf
  v_fmac_f32_dpp v43, v50, v27 row_newbcast:7 row_mask:0xf bank_mask:0xf
  v_fmac_f32_dpp v44, v50, v28 row_newbcast:7 row_mask:0xf bank_mask:0xf
  v_fmac_f32_dpp v45, v50, v29 row_newbcast:7 row_mask:0xf bank_mask:0xf
  v_fmac_f32_dpp v46, v50, v30 row_newbcast:7 row_mask:0xf bank_mask:0xf
  v_fmac_f32_dpp v47, v50, v31 row_newbcast:7 row_mask:0xf bank_mask:0xf
  s_waitcnt vmcnt(7)
  v_lshlrev_b32 v24, 16, v96
  v_and_b32 v25, s38, v96
  v_lshlrev_b32 v26, 16, v97
  v_and_b32 v27, s38, v97
  v_lshlrev_b32 v28, 16, v98
  v_and_b32 v29, s38, v98
  v_lshlrev_b32 v30, 16, v99
  v_and_b32 v31, s38, v99
  v_fmac_f32_dpp v40, v50, v24 row_newbcast:8 row_mask:0xf bank_mask:0xf
  v_fmac_f32_dpp v41, v50, v25 row_newbcast:8 row_mask:0xf bank_mask:0xf
  v_fmac_f32_dpp v42, v50, v26 row_newbcast:8 row_mask:0xf bank_mask:0xf
  v_fmac_f32_dpp v43, v50, v27 row_newbcast:8 row_mask:0xf bank_mask:0xf
  v_fmac_f32_dpp v44, v50, v28 row_newbcast:8 row_mask:0xf bank_mask:0xf
  v_fmac_f32_dpp v45, v50, v29 row_newbcast:8 row_mask:0xf bank_mask:0xf
  v_fmac_f32_dpp v46, v50, v30 row_newbcast:8 row_mask:0xf bank_mask:0xf
  v_fmac_f32_dpp v47, v50, v31 row_newbcast:8 row_mask:0xf bank_mask:0xf
  s_waitcnt vmcnt(6)
  v_lshlrev_b32 v24, 16, v100
  v_and_b32 v25, s38, v100
  v_lshlrev_b32 v26, 16, v101
  v_and_b32 v27, s38, v101
  v_lshlrev_b32 v28, 16, v102
  v_and_b32 v29, s38, v102
  v_lshlrev_b32 v30, 16, v103
  v_and_b32 v31, s38, v103
  v_fmac_f32_dpp v40, v50, v24 row_newbcast:9 row_mask:0xf bank_mask:0xf
  v_fmac_f32_dpp v41, v50, v25 row_newbcast:9 row_mask:0xf bank_mask:0xf
  v_fmac_f32_dpp v42, v50, v26 row_newbcast:9 row_mask:0xf bank_mask:0xf
  v_fmac_f32_dpp v43, v50, v27 row_newbcast:9 row_mask:0xf bank_mask:0xf
  v_fmac_f32_dpp v44, v50, v28 row_newbcast:9 row_mask:0xf bank_mask:0xf
  v_fmac_f32_dpp v45, v50, v29 row_newbcast:9 row_mask:0xf bank_mask:0xf
  v_fmac_f32_dpp v46, v50, v30 row_newbcast:9 row_mask:0xf bank_mask:0xf
  v_fmac_f32_dpp v47, v50, v31 row_newbcast:9 row_mask:0xf bank_mask:0xf
  s_waitcnt vmcnt(5)
  v_lshlrev_b32 v24, 16, v104
  v_and_b32 v25, s38, v104
  v_lshlrev_b32 v26, 16, v105
  v_and_b32 v27, s38, v105
  v_lshlrev_b32 v28, 16, v106
  v_and_b32 v29, s38, v106
  v_lshlrev_b32 v30, 16, v107
  v_and_b32 v31, s38, v107
  v_fmac_f32_dpp v40, v50, v24 row_newbcast:10 row_mask:0xf bank_mask:0xf
  v_fmac_f32_dpp v41, v50, v25 row_newbcast:10 row_mask:0xf bank_mask:0xf
  v_fmac_f32_dpp v42, v50, v26 row_newbcast:10 row_mask:0xf bank_mask:0xf
  v_fmac_f32_dpp v43, v50, v27 row_newbcast:10 row_mask:0xf bank_mask:0xf
  v_fmac_f32_dpp v44, v50, v28 row_newbcast:10 row_mask:0xf bank_mask:0xf
  v_fmac_f32_dpp v45, v50, v29 row_newbcast:10 row_mask:0xf bank_mask:0xf
  v_fmac_f32_dpp v46, v50, v30 row_newbcast:10 row_mask:0xf bank_mask:0xf
  v_fmac_f32_dpp v47, v50, v31 row_newbcast:10 row_mask:0xf bank_mask:0xf
  s_waitcnt vmcnt(4)
  v_lshlrev_b32 v24, 16, v108
  v_and_b32 v25, s38, v108
  v_lshlrev_b32 v26, 16, v109
  v_and_b32 v27, s38, v109
  v_lshlrev_b32 v28, 16, v110
  v_and_b32 v29, s38, v110
  v_lshlrev_b32 v30, 16, v111
  v_and_b32 v31, s38, v111
  v_fmac_f32_dpp v40, v50, v24 row_newbcast:11 row_mask:0xf bank_mask:0xf
  v_fmac_f32_dpp v41, v50, v25 row_newbcast:11 row_mask:0xf bank_mask:0xf
  v_fmac_f32_dpp v42, v50, v26 row_newbcast:11 row_mask:0xf bank_mask:0xf
  v_fmac_f32_dpp v43, v50, v27 row_newbcast:11 row_mask:0xf bank_mask:0xf
  v_fmac_f32_dpp v44, v50, v28 row_newbcast:11 row_mask:0xf bank_mask:0xf
  v_fmac_f32_dpp v45, v50, v29 row_newbcast:11 row_mask:0xf bank_mask:0xf
  v_fmac_f32_dpp v46, v50, v30 row_newbcast:11 row_mask:0xf bank_mask:0xf
  v_fmac_f32_dpp v47, v50, v31 row_newbcast:11 row_mask:0xf bank_mask:0xf
  s_waitcnt vmcnt(3)
  v_lshlrev_b32 v24, 16, v112
  v_and_b32 v25, s38, v112
  v_lshlrev_b32 v26, 16, v113
  v_and_b32 v27, s38, v113
  v_lshlrev_b32 v28, 16, v114
  v_and_b32 v29, s38, v114
  v_lshlrev_b32 v30, 16, v115
  v_and_b32 v31, s38, v115
  v_fmac_f32_dpp v40, v50, v24 row_newbcast:12 row_mask:0xf bank_mask:0xf
  v_fmac_f32_dpp v41, v50, v25 row_newbcast:12 row_mask:0xf bank_mask:0xf
  v_fmac_f32_dpp v42, v50, v26 row_newbcast:12 row_mask:0xf bank_mask:0xf
  v_fmac_f32_dpp v43, v50, v27 row_newbcast:12 row_mask:0xf bank_mask:0xf
  v_fmac_f32_dpp v44, v50, v28 row_newbcast:12 row_mask:0xf bank_mask:0xf
  v_fmac_f32_dpp v45, v50, v29 row_newbcast:12 row_mask:0xf bank_mask:0xf
  v_fmac_f32_dpp v46, v50, v30 row_newbcast:12 row_mask:0xf bank_mask:0xf
  v_fmac_f32_dpp v47, v50, v31 row_newbcast:12 row_mask:0xf bank_mask:0xf
  s_waitcnt vmcnt(2)
  v_lshlrev_b32 v24, 16, v116
  v_and_b32 v25, s38, v116
  v_lshlrev_b32 v26, 16, v117
  v_and_b32 v27, s38, v117
  v_lshlrev_b32 v28, 16, v118
  v_and_b32 v29, s38, v118
  v_lshlrev_b32 v30, 16, v119
  v_and_b32 v31, s38, v119
  v_fmac_f32_dpp v40, v50, v24 row_newbcast:13 row_mask:0xf bank_mask:0xf
  v_fmac_f32_dpp v41, v50, v25 row_newbcast:13 row_mask:0xf bank_mask:0xf
  v_fmac_f32_dpp v42, v50, v26 row_newbcast:13 row_mask:0xf bank_mask:0xf
  v_fmac_f32_dpp v43, v50, v27 row_newbcast:13 row_mask:0xf bank_mask:0xf
  v_fmac_f32_dpp v44, v50, v28 row_newbcast:13 row_mask:0xf bank_mask:0xf
  v_fmac_f32_dpp v45, v50, v29 row_newbcast:13 row_mask:0xf bank_mask:0xf
  v_fmac_f32_dpp v46, v50, v30 row_newbcast:13 row_mask:0xf bank_mask:0xf
  v_fmac_f32_dpp v47, v50, v31 row_newbcast:13 row_mask:0xf bank_mask:0xf
  s_waitcnt vmcnt(1)
  v_lshlrev_b32 v24, 16, v120
  v_and_b32 v25, s38, v120
  v_lshlrev_b32 v26, 16, v121
  v_and_b32 v27, s38, v121
  v_lshlrev_b32 v28, 16, v122
  v_and_b32 v29, s38, v122
  v_lshlrev_b32 v30, 16, v123
  v_and_b32 v31, s38, v123
  v_fmac_f32_dpp v40, v50, v24 row_newbcast:14 row_mask:0xf bank_mask:0xf
  v_fmac_f32_dpp v41, v50, v25 row_newbcast:14 row_mask:0xf bank_mask:0xf
  v_fmac_f32_dpp v42, v50, v26 row_newbcast:14 row_mask:0xf bank_mask:0xf
  v_fmac_f32_dpp v43, v50, v27 row_newbcast:14 row_mask:0xf bank_mask:0xf
  v_fmac_f32_dpp v44, v50, v28 row_newbcast:14 row_mask:0xf bank_mask:0xf
  v_fmac_f32_dpp v45, v50, v29 row_newbcast:14 row_mask:0xf bank_mask:0xf
  v_fmac_f32_dpp v46, v50, v30 row_newbcast:14 row_mask:0xf bank_mask:0xf
  v_fmac_f32_dpp v47, v50, v31 row_newbcast:14 row_mask:0xf bank_mask:0xf
  s_waitcnt vmcnt(0)
  v_lshlrev_b32 v24, 16, v124
  v_and_b32 v25, s38, v124
  v_lshlrev_b32 v26, 16, v125
  v_and_b32 v27, s38, v125
  v_lshlrev_b32 v28, 16, v126
  v_and_b32 v29, s38, v126
  v_lshlrev_b32 v30, 16, v127
  v_and_b32 v31, s38, v127
  v_fmac_f32_dpp v40, v50, v24 row_newbcast:15 row_mask:0xf bank_mask:0xf
  v_fmac_f32_dpp v41, v50, v25 row_newbcast:15 row_mask:0xf bank_mask:0xf
  v_fmac_f32_dpp v42, v50, v26 row_newbcast:15 row_mask:0xf bank_mask:0xf
  v_fmac_f32_dpp v43, v50, v27 row_newbcast:15 row_mask:0xf bank_mask:0xf
  v_fmac_f32_dpp v44, v50, v28 row_newbcast:15 row_mask:0xf bank_mask:0xf
  v_fmac_f32_dpp v45, v50, v29 row_newbcast:15 row_mask:0xf bank_mask:0xf
  v_fmac_f32_dpp v46, v50, v30 row_newbcast:15 row_mask:0xf bank_mask:0xf
  v_fmac_f32_dpp v47, v50, v31 row_newbcast:15 row_mask:0xf bank_mask:0xf
  v_permlane32_swap_b32 v40, v44
  v_permlane32_swap_b32 v41, v45
  v_permlane32_swap_b32 v42, v46
  v_permlane32_swap_b32 v43, v47
  v_add_f32 v40, v40, v44
  v_add_f32 v41, v41, v45
  v_add_f32 v42, v42, v46
  v_add_f32 v43, v43, v47
  s_nop 0
  v_permlane16_swap_b32 v40, v42
  v_permlane16_swap_b32 v41, v43
  v_add_f32 v40, v40, v42
  v_add_f32 v41, v41, v43
  ds_write_b64 v3, v[40:41] offset:23552
  s_waitcnt lgkmcnt(0)
  s_barrier
  s_cmp_ge_u32 s30, 1
  s_cbranch_scc1 L_att_other
  s_mul_i32 s50, s31, 1152
  s_lshl_b32 s51, s45, 6
  s_add_u32 s52, s50, s51
  s_mov_b32 s32, s4
  s_and_b32 s33, s5, 0xffff
  s_mov_b32 s34, 9216
  s_mov_b32 s35, 0x20000
  s_mov_b32 s40, s22
  s_and_b32 s41, s23, 0xffff
  s_mov_b32 s42, 1152
  s_mov_b32 s43, 0x20000
  v_and_b32 v6, 7, v1
  v_lshrrev_b32 v5, 4, v1
  v_lshlrev_b32 v4, 3, v6
  v_lshl_add_u32 v4, v5, 1, v4
  v_add_u32 v5, s51, v4
  v_add_u32 v4, s52, v4
  buffer_load_ushort v8, v4, s[32:35], 0 offen
  buffer_load_ushort v10, v5, s[40:43], 0 offen
  v_lshrrev_b32 v7, 3, v1
  v_lshlrev_b32 v12, 12, v7
  v_lshl_add_u32 v12, v6, 4, v12
  v_add_u32 v13, 0x8000, v12
  v_add_u32 v14, 0x10000, v12
  v_cmp_gt_u32 vcc, 16, v1
  v_mov_b32 v15, 0x80000000
  s_nop 0
  v_cndmask_b32 v14, v15, v14, vcc
  v_lshlrev_b32 v16, 7, v7
  v_lshl_add_u32 v16, v6, 4, v16
  v_lshlrev_b32 v7, 4, v1
  v_add_u32 v2, 2048, v7
  v_min_u32 v2, 2288, v2
  s_mul_i32 s50, s31, 73728
  s_lshl_b32 s51, s39, 7
  s_add_u32 s51, s51, s50
  s_add_u32 s68, s28, s51
  s_addc_u32 s69, s29, 0
  s_and_b32 s69, s69, 0xffff
  s_mov_b32 s70, 73728
  s_mov_b32 s71, 0x20000
  s_lshl_b32 s51, s45, 12
  s_add_u32 s51, s51, s50
  s_add_u32 s72, s28, s51
  s_addc_u32 s73, s29, 0
  s_and_b32 s73, s73, 0xffff
  s_mov_b32 s74, 4096
  s_mov_b32 s75, 0x20000
  s_mov_b32 s76, s24
  s_and_b32 s77, s25, 0xffff
  s_mov_b32 s78, 9216
  s_mov_b32 s79, 0x20000
  s_waitcnt vmcnt(0)
  v_lshlrev_b32 v8, 16, v8
  v_lshlrev_b32 v10, 16, v10
  v_add_f32 v8, v8, v10
  s_barrier
  ds_read_b128 v[64:67], v7 offset:24064
  ds_read_b128 v[68:71], v7 offset:25088
  ds_read_b128 v[72:75], v2 offset:24064
  ds_read_b128 v[76:79], v7 offset:26368
  ds_read_b128 v[80:83], v7 offset:27392
  ds_read_b128 v[84:87], v2 offset:26368
  ds_read_b128 v[88:91], v7 offset:28672
  ds_read_b128 v[92:95], v7 offset:29696
  ds_read_b128 v[96:99], v2 offset:28672
  ds_read_b128 v[100:103], v7 offset:30976
  ds_read_b128 v[104:107], v7 offset:32000
  ds_read_b128 v[108:111], v2 offset:30976
  s_waitcnt lgkmcnt(6)
  v_add_f32 v32, v64, v76
  v_add_f32 v33, v65, v77
  v_add_f32 v34, v66, v78
  v_add_f32 v35, v67, v79
  v_add_f32 v36, v68, v80
  v_add_f32 v37, v69, v81
  v_add_f32 v38, v70, v82
  v_add_f32 v39, v71, v83
  v_add_f32 v40, v72, v84
  v_add_f32 v41, v73, v85
  v_add_f32 v42, v74, v86
  v_add_f32 v43, v75, v87
  s_waitcnt lgkmcnt(0)
  v_add_f32 v88, v88, v100
  v_add_f32 v89, v89, v101
  v_add_f32 v90, v90, v102
  v_add_f32 v91, v91, v103
  v_add_f32 v92, v92, v104
  v_add_f32 v93, v93, v105
  v_add_f32 v94, v94, v106
  v_add_f32 v95, v95, v107
  v_add_f32 v96, v96, v108
  v_add_f32 v97, v97, v109
  v_add_f32 v98, v98, v110
  v_add_f32 v99, v99, v111
  v_add_f32 v32, v32, v88
  v_add_f32 v33, v33, v89
  v_add_f32 v34, v34, v90
  v_add_f32 v35, v35, v91
  v_add_f32 v36, v36, v92
  v_add_f32 v37, v37, v93
  v_add_f32 v38, v38, v94
  v_add_f32 v39, v39, v95
  v_add_f32 v40, v40, v96
  v_add_f32 v41, v41, v97
  v_add_f32 v42, v42, v98
  v_add_f32 v43, v43, v99
  buffer_store_dwordx4 v[32:35], v12, s[68:71], 0 offen sc1
  buffer_store_dwordx4 v[36:39], v13, s[68:71], 0 offen sc1
  buffer_store_dwordx4 v[40:43], v14, s[68:71], 0 offen sc1
  s_cmp_ge_u32 s45, 18
  s_cbranch_scc1 L_fin0
L_gstart:
  s_mov_b32 s37, 0x40000
L_gather:
  buffer_load_dwordx4 v[64:67], v16, s[72:75], 0 offen offset:0 sc1
  buffer_load_dwordx4 v[68:71], v16, s[72:75], 0 offen offset:1024 sc1
  buffer_load_dwordx4 v[72:75], v16, s[72:75], 0 offen offset:2048 sc1
  buffer_load_dwordx4 v[76:79], v16, s[72:75], 0 offen offset:3072 sc1
  s_waitcnt vmcnt(0)
  v_max3_u32 v24, v64, v65, v66
  v_max3_u32 v24, v24, v67, v68
  v_max3_u32 v24, v24, v69, v70
  v_max3_u32 v24, v24, v71, v72
  v_max3_u32 v24, v24, v73, v74
  v_max3_u32 v24, v24, v75, v76
  v_max3_u32 v24, v24, v77, v78
  v_max_u32 v24, v24, v79
  v_cmp_eq_u32 vcc, -1, v24
  s_sub_u32 s37, s37, 1
  s_cbranch_scc1 L_gdone
  s_nop 3
  s_cbranch_vccnz L_gather
L_gdone:
  v_add_f32 v64, v64, v68
  v_add_f32 v72, v72, v76
  v_add_f32 v65, v65, v69
  v_add_f32 v73, v73, v77
  v_add_f32 v66, v66, v70
  v_add_f32 v74, v74, v78
  v_add_f32 v67, v67, v71
  v_add_f32 v75, v75, v79
  v_add_f32 v64, v64, v72
  v_add_f32 v65, v65, v73
  v_add_f32 v66, v66, v74
  v_add_f32 v67, v67, v75
  s_nop 0
  v_permlane32_swap_b32 v64, v66
  v_permlane32_swap_b32 v65, v67
  v_add_f32 v64, v64, v66
  v_add_f32 v65, v65, v67
  s_nop 1
  v_permlane16_swap_b32 v64, v65
  v_add_f32 v64, v64, v65
  s_nop 1
  v_add_f32_dpp v64, v64, v64 row_ror:8 row_mask:0xf bank_mask:0xf
  v_add_f32 v64, v64, v8
  v_cvt_pk_bf16_f32 v56, v64, v64
  s_mov_b32 exec_lo, 0x00ff00ff
  s_mov_b32 exec_hi, 0x00ff00ff
  buffer_store_short v56, v4, s[76:79], 0 offen sc1
L_fin0:
  s_endpgm
L_att_other:
  s_barrier
  s_endpgm
L_weights:
  s_sub_u32 s64, s30, 4
  v_lshrrev_b32 v2, 4, v1
  v_and_b32 v3, 15, v1
  v_lshlrev_b32 v4, 1, v1
  v_lshlrev_b32 v5, 13, v2
  v_lshl_add_u32 v5, v3, 4, v5
  s_mul_i32 s50, s64, 1179648
  s_lshl_b32 s51, s39, 8
  s_add_u32 s50, s50, s51
  v_add_u32 v5, s50, v5
  s_mul_i32 s50, s31, 1152
  s_waitcnt lgkmcnt(0)
  s_add_u32 s40, s4, s50
  s_addc_u32 s41, s5, 0
  s_and_b32 s41, s41, 0xffff
  s_mov_b32 s42, 1152
  s_mov_b32 s43, 0x20000
  s_mov_b32 s32, s10
  s_and_b32 s33, s11, 0xffff
  s_mov_b32 s34, 4718592
  s_mov_b32 s35, 0x20000
  buffer_load_ushort v8, v4, s[40:43], 0 offen offset:0
  buffer_load_ushort v9, v4, s[40:43], 0 offen offset:128
  buffer_load_ushort v10, v4, s[40:43], 0 offen offset:256
  buffer_load_ushort v11, v4, s[40:43], 0 offen offset:384
  buffer_load_ushort v12, v4, s[40:43], 0 offen offset:512
  buffer_load_ushort v13, v4, s[40:43], 0 offen offset:640
  buffer_load_ushort v14, v4, s[40:43], 0 offen offset:768
  buffer_load_ushort v15, v4, s[40:43], 0 offen offset:896
  buffer_load_ushort v16, v4, s[40:43], 0 offen offset:1024
  s_mov_b32 s36, 0
  buffer_load_dwordx4 v[64:67], v5, s[32:35], s36 offen
  s_add_u32 s36, s36, 32768
  buffer_load_dwordx4 v[68:71], v5, s[32:35], s36 offen
  s_add_u32 s36, s36, 32768
  v_mov_b32 v6, 0
  ds_write_b32 v6, v6 offset:6720
  ds_write_b32 v6, v6 offset:6724
  s_waitcnt lgkmcnt(0)
  s_barrier
  s_waitcnt vmcnt(2)
  v_lshlrev_b32 v8, 16, v8
  v_lshlrev_b32 v9, 16, v9
  v_lshlrev_b32 v10, 16, v10
  v_lshlrev_b32 v11, 16, v11
  v_lshlrev_b32 v12, 16, v12
  v_lshlrev_b32 v13, 16, v13
  v_lshlrev_b32 v14, 16, v14
  v_lshlrev_b32 v15, 16, v15
  v_lshlrev_b32 v16, 16, v16
  v_add_f32 v32, v8, v9
  v_add_f32 v32, v32, v10
  v_add_f32 v32, v32, v11
  v_add_f32 v32, v32, v12
  v_add_f32 v32, v32, v13
  v_add_f32 v32, v32, v14
  v_add_f32 v32, v32, v15
  v_add_f32 v32, v32, v16
  s_nop 1
  v_add_f32_dpp v32, v32, v32 row_ror:8 row_mask:0xf bank_mask:0xf
  s_nop 1
  v_add_f32_dpp v32, v32, v32 row_ror:4 row_mask:0xf bank_mask:0xf
  s_nop 1
  v_add_f32_dpp v32, v32, v32 row_ror:2 row_mask:0xf bank_mask:0xf
  s_nop 1
  v_add_f32_dpp v32, v32, v32 row_ror:1 row_mask:0xf bank_mask:0xf
  v_mov_b32 v33, v32
  s_nop 1
  v_permlane16_swap_b32 v32, v33
  v_add_f32 v32, v32, v33
  v_mov_b32 v33, v32
  s_nop 1
  v_permlane32_swap_b32 v32, v33
  v_add_f32 v32, v32, v33
  v_mov_b32 v39, 0x44100000
  v_rcp_f32 v36, v39
  s_nop 0
  v_mul_f32 v34, v32, v36
  v_fma_f32 v37, -v34, v39, v32
  v_fma_f32 v34, v37, v36, v34
  v_mov_b32 v35, v34
  v_cvt_pk_bf16_f32 v35, v35, v35
  v_and_b32 v35, s38, v35
  v_sub_f32 v20, v8, v34
  v_sub_f32 v21, v9, v34
  v_sub_f32 v22, v10, v34
  v_sub_f32 v23, v11, v34
  v_sub_f32 v24, v12, v34
  v_sub_f32 v25, v13, v34
  v_sub_f32 v26, v14, v34
  v_sub_f32 v27, v15, v34
  v_sub_f32 v28, v16, v34
  v_mul_f32 v32, v20, v20
  v_fmac_f32 v32, v21, v21
  v_fmac_f32 v32, v22, v22
  v_fmac_f32 v32, v23, v23
  v_fmac_f32 v32, v24, v24
  v_fmac_f32 v32, v25, v25
  v_fmac_f32 v32, v26, v26
  v_fmac_f32 v32, v27, v27
  v_fmac_f32 v32, v28, v28
  s_nop 1
  v_add_f32_dpp v32, v32, v32 row_ror:8 row_mask:0xf bank_mask:0xf
  s_nop 1
  v_add_f32_dpp v32, v32, v32 row_ror:4 row_mask:0xf bank_mask:0xf
  s_nop 1
  v_add_f32_dpp v32, v32, v32 row_ror:2 row_mask:0xf bank_mask:0xf
  s_nop 1
  v_add_f32_dpp v32, v32, v32 row_ror:1 row_mask:0xf bank_mask:0xf
  v_mov_b32 v33, v32
  s_nop 1
  v_permlane16_swap_b32 v32, v33
  v_add_f32 v32, v32, v33
  v_mov_b32 v33, v32
  s_nop 1
  v_permlane32_swap_b32 v32, v33
  v_add_f32 v32, v32, v33
  v_mul_f32 v38, v32, v36
  v_fma_f32 v37, -v38, v39, v32
  v_fma_f32 v38, v37, v36, v38
  v_cvt_pk_bf16_f32 v38, v38, v38
  v_and_b32 v38, s38, v38
  v_add_f32 v38, 0x3727c5ac, v38
  v_cvt_pk_bf16_f32 v38, v38, v38
  v_and_b32 v38, s38, v38
  v_sqrt_f32 v38, v38
  s_nop 0
  v_cvt_pk_bf16_f32 v38, v38, v38
  v_and_b32 v38, s38, v38
  v_rcp_f32 v36, v38
  v_sub_f32 v20, v8, v35
  v_cvt_pk_bf16_f32 v20, v20, v20
  v_and_b32 v20, s38, v20
  v_mov_b32 v33, v20
  v_mul_f32 v20, v33, v36
  v_fma_f32 v37, -v20, v38, v33
  v_fma_f32 v20, v37, v36, v20
  v_cvt_pk_bf16_f32 v20, v20, v20
  v_and_b32 v20, s38, v20
  v_sub_f32 v21, v9, v35
  v_cvt_pk_bf16_f32 v21, v21, v21
  v_and_b32 v21, s38, v21
  v_mov_b32 v33, v21
  v_mul_f32 v21, v33, v36
  v_fma_f32 v37, -v21, v38, v33
  v_fma_f32 v21, v37, v36, v21
  v_cvt_pk_bf16_f32 v21, v21, v21
  v_and_b32 v21, s38, v21
  v_sub_f32 v22, v10, v35
  v_cvt_pk_bf16_f32 v22, v22, v22
  v_and_b32 v22, s38, v22
  v_mov_b32 v33, v22
  v_mul_f32 v22, v33, v36
  v_fma_f32 v37, -v22, v38, v33
  v_fma_f32 v22, v37, v36, v22
  v_cvt_pk_bf16_f32 v22, v22, v22
  v_and_b32 v22, s38, v22
  v_sub_f32 v23, v11, v35
  v_cvt_pk_bf16_f32 v23, v23, v23
  v_and_b32 v23, s38, v23
  v_mov_b32 v33, v23
  v_mul_f32 v23, v33, v36
  v_fma_f32 v37, -v23, v38, v33
  v_fma_f32 v23, v37, v36, v23
  v_cvt_pk_bf16_f32 v23, v23, v23
  v_and_b32 v23, s38, v23
  v_sub_f32 v24, v12, v35
  v_cvt_pk_bf16_f32 v24, v24, v24
  v_and_b32 v24, s38, v24
  v_mov_b32 v33, v24
  v_mul_f32 v24, v33, v36
  v_fma_f32 v37, -v24, v38, v33
  v_fma_f32 v24, v37, v36, v24
  v_cvt_pk_bf16_f32 v24, v24, v24
  v_and_b32 v24, s38, v24
  v_sub_f32 v25, v13, v35
  v_cvt_pk_bf16_f32 v25, v25, v25
  v_and_b32 v25, s38, v25
  v_mov_b32 v33, v25
  v_mul_f32 v25, v33, v36
  v_fma_f32 v37, -v25, v38, v33
  v_fma_f32 v25, v37, v36, v25
  v_cvt_pk_bf16_f32 v25, v25, v25
  v_and_b32 v25, s38, v25
  v_sub_f32 v26, v14, v35
  v_cvt_pk_bf16_f32 v26, v26, v26
  v_and_b32 v26, s38, v26
  v_mov_b32 v33, v26
  v_mul_f32 v26, v33, v36
  v_fma_f32 v37, -v26, v38, v33
  v_fma_f32 v26, v37, v36, v26
  v_cvt_pk_bf16_f32 v26, v26, v26
  v_and_b32 v26, s38, v26
  v_sub_f32 v27, v15, v35
  v_cvt_pk_bf16_f32 v27, v27, v27
  v_and_b32 v27, s38, v27
  v_mov_b32 v33, v27
  v_mul_f32 v27, v33, v36
  v_fma_f32 v37, -v27, v38, v33
  v_fma_f32 v27, v37, v36, v27
  v_cvt_pk_bf16_f32 v27, v27, v27
  v_and_b32 v27, s38, v27
  v_sub_f32 v28, v16, v35
  v_cvt_pk_bf16_f32 v28, v28, v28
  v_and_b32 v28, s38, v28
  v_mov_b32 v33, v28
  v_mul_f32 v28, v33, v36
  v_fma_f32 v37, -v28, v38, v33
  v_fma_f32 v28, v37, v36, v28
  v_cvt_pk_bf16_f32 v28, v28, v28
  v_and_b32 v28, s38, v28
  v_lshlrev_b32 v6, 2, v1
  ds_write_b32 v6, v20 offset:0
  ds_write_b32 v6, v21 offset:256
  ds_write_b32 v6, v22 offset:512
  ds_write_b32 v6, v23 offset:768
  ds_write_b32 v6, v24 offset:1024
  ds_write_b32 v6, v25 offset:1280
  ds_write_b32 v6, v26 offset:1536
  ds_write_b32 v6, v27 offset:1792
  ds_write_b32 v6, v28 offset:2048
  buffer_load_dwordx4 v[72:75], v5, s[32:35], s36 offen
  s_add_u32 s36, s36, 32768
  s_mul_i32 s50, s64, 576
  v_lshlrev_b32 v7, 2, v2
  v_add_u32 v7, s50, v7
  s_waitcnt lgkmcnt(0)
  ds_read_b32 v208, v7 offset:0
  ds_read_b32 v209, v7 offset:16
  ds_read_b32 v210, v7 offset:32
  ds_read_b32 v211, v7 offset:48
  ds_read_b32 v212, v7 offset:64
  ds_read_b32 v213, v7 offset:80
  ds_read_b32 v214, v7 offset:96
  ds_read_b32 v215, v7 offset:112
  ds_read_b32 v216, v7 offset:128
  ds_read_b32 v217, v7 offset:144
  ds_read_b32 v218, v7 offset:160
  ds_read_b32 v219, v7 offset:176
  ds_read_b32 v220, v7 offset:192
  ds_read_b32 v221, v7 offset:208
  ds_read_b32 v222, v7 offset:224
  s_waitcnt lgkmcnt(0)
  ds_read_b32 v223, v7 offset:240
  ds_read_b32 v224, v7 offset:256
  ds_read_b32 v225, v7 offset:272
  ds_read_b32 v226, v7 offset:288
  ds_read_b32 v227, v7 offset:304
  ds_read_b32 v228, v7 offset:320
  ds_read_b32 v229, v7 offset:336
  ds_read_b32 v230, v7 offset:352
  ds_read_b32 v231, v7 offset:368
  ds_read_b32 v232, v7 offset:384
  ds_read_b32 v233, v7 offset:400
  ds_read_b32 v234, v7 offset:416
  ds_read_b32 v235, v7 offset:432
  ds_read_b32 v236, v7 offset:448
  ds_read_b32 v237, v7 offset:464
  s_waitcnt lgkmcnt(0)
  ds_read_b32 v238, v7 offset:480
  ds_read_b32 v239, v7 offset:496
  ds_read_b32 v240, v7 offset:512
  ds_read_b32 v241, v7 offset:528
  ds_read_b32 v242, v7 offset:544
  ds_read_b32 v243, v7 offset:560
  v_mov_b32 v40, 0
  v_mov_b32 v41, 0
  v_mov_b32 v42, 0
  v_mov_b32 v43, 0
  v_mov_b32 v44, 0
  v_mov_b32 v45, 0
  v_mov_b32 v46, 0
  v_mov_b32 v47, 0
  s_waitcnt lgkmcnt(0)
  s_waitcnt vmcnt(2)
  buffer_load_dwordx4 v[76:79], v5, s[32:35], s36 offen
  s_add_u32 s36, s36, 32768
  v_lshlrev_b32 v32, 16, v64
  v_and_b32 v33, s38, v64
  v_lshlrev_b32 v34, 16, v65
  v_and_b32 v35, s38, v65
  v_lshlrev_b32 v36, 16, v66
  v_and_b32 v37, s38, v66
  v_lshlrev_b32 v38, 16, v67
  v_and_b32 v39, s38, v67
  v_fmac_f32 v40, v208, v32
  v_fmac_f32 v41, v208, v33
  v_fmac_f32 v42, v208, v34
  v_fmac_f32 v43, v208, v35
  v_fmac_f32 v44, v208, v36
  v_fmac_f32 v45, v208, v37
  v_fmac_f32 v46, v208, v38
  v_fmac_f32 v47, v208, v39
  s_waitcnt vmcnt(2)
  buffer_load_dwordx4 v[80:83], v5, s[32:35], s36 offen
  s_add_u32 s36, s36, 32768
  v_lshlrev_b32 v32, 16, v68
  v_and_b32 v33, s38, v68
  v_lshlrev_b32 v34, 16, v69
  v_and_b32 v35, s38, v69
  v_lshlrev_b32 v36, 16, v70
  v_and_b32 v37, s38, v70
  v_lshlrev_b32 v38, 16, v71
  v_and_b32 v39, s38, v71
  v_fmac_f32 v40, v209, v32
  v_fmac_f32 v41, v209, v33
  v_fmac_f32 v42, v209, v34
  v_fmac_f32 v43, v209, v35
  v_fmac_f32 v44, v209, v36
  v_fmac_f32 v45, v209, v37
  v_fmac_f32 v46, v209, v38
  v_fmac_f32 v47, v209, v39
  s_waitcnt vmcnt(2)
  buffer_load_dwordx4 v[84:87], v5, s[32:35], s36 offen
  s_add_u32 s36, s36, 32768
  v_lshlrev_b32 v32, 16, v72
  v_and_b32 v33, s38, v72
  v_lshlrev_b32 v34, 16, v73
  v_and_b32 v35, s38, v73
  v_lshlrev_b32 v36, 16, v74
  v_and_b32 v37, s38, v74
  v_lshlrev_b32 v38, 16, v75
  v_and_b32 v39, s38, v75
  v_fmac_f32 v40, v210, v32
  v_fmac_f32 v41, v210, v33
  v_fmac_f32 v42, v210, v34
  v_fmac_f32 v43, v210, v35
  v_fmac_f32 v44, v210, v36
  v_fmac_f32 v45, v210, v37
  v_fmac_f32 v46, v210, v38
  v_fmac_f32 v47, v210, v39
  s_waitcnt vmcnt(2)
  buffer_load_dwordx4 v[88:91], v5, s[32:35], s36 offen
  s_add_u32 s36, s36, 32768
  v_lshlrev_b32 v32, 16, v76
  v_and_b32 v33, s38, v76
  v_lshlrev_b32 v34, 16, v77
  v_and_b32 v35, s38, v77
  v_lshlrev_b32 v36, 16, v78
  v_and_b32 v37, s38, v78
  v_lshlrev_b32 v38, 16, v79
  v_and_b32 v39, s38, v79
  v_fmac_f32 v40, v211, v32
  v_fmac_f32 v41, v211, v33
  v_fmac_f32 v42, v211, v34
  v_fmac_f32 v43, v211, v35
  v_fmac_f32 v44, v211, v36
  v_fmac_f32 v45, v211, v37
  v_fmac_f32 v46, v211, v38
  v_fmac_f32 v47, v211, v39
  s_waitcnt vmcnt(2)
  buffer_load_dwordx4 v[92:95], v5, s[32:35], s36 offen
  s_add_u32 s36, s36, 32768
  v_lshlrev_b32 v32, 16, v80
  v_and_b32 v33, s38, v80
  v_lshlrev_b32 v34, 16, v81
  v_and_b32 v35, s38, v81
  v_lshlrev_b32 v36, 16, v82
  v_and_b32 v37, s38, v82
  v_lshlrev_b32 v38, 16, v83
  v_and_b32 v39, s38, v83
  v_fmac_f32 v40, v212, v32
  v_fmac_f32 v41, v212, v33
  v_fmac_f32 v42, v212, v34
  v_fmac_f32 v43, v212, v35
  v_fmac_f32 v44, v212, v36
  v_fmac_f32 v45, v212, v37
  v_fmac_f32 v46, v212, v38
  v_fmac_f32 v47, v212, v39
  s_waitcnt vmcnt(2)
  buffer_load_dwordx4 v[96:99], v5, s[32:35], s36 offen
  s_add_u32 s36, s36, 32768
  v_lshlrev_b32 v32, 16, v84
  v_and_b32 v33, s38, v84
  v_lshlrev_b32 v34, 16, v85
  v_and_b32 v35, s38, v85
  v_lshlrev_b32 v36, 16, v86
  v_and_b32 v37, s38, v86
  v_lshlrev_b32 v38, 16, v87
  v_and_b32 v39, s38, v87
  v_fmac_f32 v40, v213, v32
  v_fmac_f32 v41, v213, v33
  v_fmac_f32 v42, v213, v34
  v_fmac_f32 v43, v213, v35
  v_fmac_f32 v44, v213, v36
  v_fmac_f32 v45, v213, v37
  v_fmac_f32 v46, v213, v38
  v_fmac_f32 v47, v213, v39
  s_waitcnt vmcnt(2)
  buffer_load_dwordx4 v[100:103], v5, s[32:35], s36 offen
  s_add_u32 s36, s36, 32768
  v_lshlrev_b32 v32, 16, v88
  v_and_b32 v33, s38, v88
  v_lshlrev_b32 v34, 16, v89
  v_and_b32 v35, s38, v89
  v_lshlrev_b32 v36, 16, v90
  v_and_b32 v37, s38, v90
  v_lshlrev_b32 v38, 16, v91
  v_and_b32 v39, s38, v91
  v_fmac_f32 v40, v214, v32
  v_fmac_f32 v41, v214, v33
  v_fmac_f32 v42, v214, v34
  v_fmac_f32 v43, v214, v35
  v_fmac_f32 v44, v214, v36
  v_fmac_f32 v45, v214, v37
  v_fmac_f32 v46, v214, v38
  v_fmac_f32 v47, v214, v39
  s_waitcnt vmcnt(2)
  buffer_load_dwordx4 v[104:107], v5, s[32:35], s36 offen
  s_add_u32 s36, s36, 32768
  v_lshlrev_b32 v32, 16, v92
  v_and_b32 v33, s38, v92
  v_lshlrev_b32 v34, 16, v93
  v_and_b32 v35, s38, v93
  v_lshlrev_b32 v36, 16, v94
  v_and_b32 v37, s38, v94
  v_lshlrev_b32 v38, 16, v95
  v_and_b32 v39, s38, v95
  v_fmac_f32 v40, v215, v32
  v_fmac_f32 v41, v215, v33
  v_fmac_f32 v42, v215, v34
  v_fmac_f32 v43, v215, v35
  v_fmac_f32 v44, v215, v36
  v_fmac_f32 v45, v215, v37
  v_fmac_f32 v46, v215, v38
  v_fmac_f32 v47, v215, v39
  s_waitcnt vmcnt(2)
  buffer_load_dwordx4 v[108:111], v5, s[32:35], s36 offen
  s_add_u32 s36, s36, 32768
  v_lshlrev_b32 v32, 16, v96
  v_and_b32 v33, s38, v96
  v_lshlrev_b32 v34, 16, v97
  v_and_b32 v35, s38, v97
  v_lshlrev_b32 v36, 16, v98
  v_and_b32 v37, s38, v98
  v_lshlrev_b32 v38, 16, v99
  v_and_b32 v39, s38, v99
  v_fmac_f32 v40, v216, v32
  v_fmac_f32 v41, v216, v33
  v_fmac_f32 v42, v216, v34
  v_fmac_f32 v43, v216, v35
  v_fmac_f32 v44, v216, v36
  v_fmac_f32 v45, v216, v37
  v_fmac_f32 v46, v216, v38
  v_fmac_f32 v47, v216, v39
  s_waitcnt vmcnt(2)
  buffer_load_dwordx4 v[112:115], v5, s[32:35], s36 offen
  s_add_u32 s36, s36, 32768
  v_lshlrev_b32 v32, 16, v100
  v_and_b32 v33, s38, v100
  v_lshlrev_b32 v34, 16, v101
  v_and_b32 v35, s38, v101
  v_lshlrev_b32 v36, 16, v102
  v_and_b32 v37, s38, v102
  v_lshlrev_b32 v38, 16, v103
  v_and_b32 v39, s38, v103
  v_fmac_f32 v40, v217, v32
  v_fmac_f32 v41, v217, v33
  v_fmac_f32 v42, v217, v34
  v_fmac_f32 v43, v217, v35
  v_fmac_f32 v44, v217, v36
  v_fmac_f32 v45, v217, v37
  v_fmac_f32 v46, v217, v38
  v_fmac_f32 v47, v217, v39
  s_waitcnt vmcnt(2)
  buffer_load_dwordx4 v[116:119], v5, s[32:35], s36 offen
  s_add_u32 s36, s36, 32768
  v_lshlrev_b32 v32, 16, v104
  v_and_b32 v33, s38, v104
  v_lshlrev_b32 v34, 16, v105
  v_and_b32 v35, s38, v105
  v_lshlrev_b32 v36, 16, v106
  v_and_b32 v37, s38, v106
  v_lshlrev_b32 v38, 16, v107
  v_and_b32 v39, s38, v107
  v_fmac_f32 v40, v218, v32
  v_fmac_f32 v41, v218, v33
  v_fmac_f32 v42, v218, v34
  v_fmac_f32 v43, v218, v35
  v_fmac_f32 v44, v218, v36
  v_fmac_f32 v45, v218, v37
  v_fmac_f32 v46, v218, v38
  v_fmac_f32 v47, v218, v39
  s_waitcnt vmcnt(2)
  buffer_load_dwordx4 v[120:123], v5, s[32:35], s36 offen
  s_add_u32 s36, s36, 32768
  v_lshlrev_b32 v32, 16, v108
  v_and_b32 v33, s38, v108
  v_lshlrev_b32 v34, 16, v109
  v_and_b32 v35, s38, v109
  v_lshlrev_b32 v36, 16, v110
  v_and_b32 v37, s38, v110
  v_lshlrev_b32 v38, 16, v111
  v_and_b32 v39, s38, v111
  v_fmac_f32 v40, v219, v32
  v_fmac_f32 v41, v219, v33
  v_fmac_f32 v42, v219, v34
  v_fmac_f32 v43, v219, v35
  v_fmac_f32 v44, v219, v36
  v_fmac_f32 v45, v219, v37
  v_fmac_f32 v46, v219, v38
  v_fmac_f32 v47, v219, v39
  s_waitcnt vmcnt(2)
  buffer_load_dwordx4 v[124:127], v5, s[32:35], s36 offen
  s_add_u32 s36, s36, 32768
  v_lshlrev_b32 v32, 16, v112
  v_and_b32 v33, s38, v112
  v_lshlrev_b32 v34, 16, v113
  v_and_b32 v35, s38, v113
  v_lshlrev_b32 v36, 16, v114
  v_and_b32 v37, s38, v114
  v_lshlrev_b32 v38, 16, v115
  v_and_b32 v39, s38, v115
  v_fmac_f32 v40, v220, v32
  v_fmac_f32 v41, v220, v33
  v_fmac_f32 v42, v220, v34
  v_fmac_f32 v43, v220, v35
  v_fmac_f32 v44, v220, v36
  v_fmac_f32 v45, v220, v37
  v_fmac_f32 v46, v220, v38
  v_fmac_f32 v47, v220, v39
  s_waitcnt vmcnt(2)
  buffer_load_dwordx4 v[128:131], v5, s[32:35], s36 offen
  s_add_u32 s36, s36, 32768
  v_lshlrev_b32 v32, 16, v116
  v_and_b32 v33, s38, v116
  v_lshlrev_b32 v34, 16, v117
  v_and_b32 v35, s38, v117
  v_lshlrev_b32 v36, 16, v118
  v_and_b32 v37, s38, v118
  v_lshlrev_b32 v38, 16, v119
  v_and_b32 v39, s38, v119
  v_fmac_f32 v40, v221, v32
  v_fmac_f32 v41, v221, v33
  v_fmac_f32 v42, v221, v34
  v_fmac_f32 v43, v221, v35
  v_fmac_f32 v44, v221, v36
  v_fmac_f32 v45, v221, v37
  v_fmac_f32 v46, v221, v38
  v_fmac_f32 v47, v221, v39
  s_waitcnt vmcnt(2)
  buffer_load_dwordx4 v[132:135], v5, s[32:35], s36 offen
  s_add_u32 s36, s36, 32768
  v_lshlrev_b32 v32, 16, v120
  v_and_b32 v33, s38, v120
  v_lshlrev_b32 v34, 16, v121
  v_and_b32 v35, s38, v121
  v_lshlrev_b32 v36, 16, v122
  v_and_b32 v37, s38, v122
  v_lshlrev_b32 v38, 16, v123
  v_and_b32 v39, s38, v123
  v_fmac_f32 v40, v222, v32
  v_fmac_f32 v41, v222, v33
  v_fmac_f32 v42, v222, v34
  v_fmac_f32 v43, v222, v35
  v_fmac_f32 v44, v222, v36
  v_fmac_f32 v45, v222, v37
  v_fmac_f32 v46, v222, v38
  v_fmac_f32 v47, v222, v39
  s_waitcnt vmcnt(2)
  buffer_load_dwordx4 v[136:139], v5, s[32:35], s36 offen
  s_add_u32 s36, s36, 32768
  v_lshlrev_b32 v32, 16, v124
  v_and_b32 v33, s38, v124
  v_lshlrev_b32 v34, 16, v125
  v_and_b32 v35, s38, v125
  v_lshlrev_b32 v36, 16, v126
  v_and_b32 v37, s38, v126
  v_lshlrev_b32 v38, 16, v127
  v_and_b32 v39, s38, v127
  v_fmac_f32 v40, v223, v32
  v_fmac_f32 v41, v223, v33
  v_fmac_f32 v42, v223, v34
  v_fmac_f32 v43, v223, v35
  v_fmac_f32 v44, v223, v36
  v_fmac_f32 v45, v223, v37
  v_fmac_f32 v46, v223, v38
  v_fmac_f32 v47, v223, v39
  s_waitcnt vmcnt(2)
  buffer_load_dwordx4 v[140:143], v5, s[32:35], s36 offen
  s_add_u32 s36, s36, 32768
  v_lshlrev_b32 v32, 16, v128
  v_and_b32 v33, s38, v128
  v_lshlrev_b32 v34, 16, v129
  v_and_b32 v35, s38, v129
  v_lshlrev_b32 v36, 16, v130
  v_and_b32 v37, s38, v130
  v_lshlrev_b32 v38, 16, v131
  v_and_b32 v39, s38, v131
  v_fmac_f32 v40, v224, v32
  v_fmac_f32 v41, v224, v33
  v_fmac_f32 v42, v224, v34
  v_fmac_f32 v43, v224, v35
  v_fmac_f32 v44, v224, v36
  v_fmac_f32 v45, v224, v37
  v_fmac_f32 v46, v224, v38
  v_fmac_f32 v47, v224, v39
  s_waitcnt vmcnt(2)
  buffer_load_dwordx4 v[144:147], v5, s[32:35], s36 offen
  s_add_u32 s36, s36, 32768
  v_lshlrev_b32 v32, 16, v132
  v_and_b32 v33, s38, v132
  v_lshlrev_b32 v34, 16, v133
  v_and_b32 v35, s38, v133
  v_lshlrev_b32 v36, 16, v134
  v_and_b32 v37, s38, v134
  v_lshlrev_b32 v38, 16, v135
  v_and_b32 v39, s38, v135
  v_fmac_f32 v40, v225, v32
  v_fmac_f32 v41, v225, v33
  v_fmac_f32 v42, v225, v34
  v_fmac_f32 v43, v225, v35
  v_fmac_f32 v44, v225, v36
  v_fmac_f32 v45, v225, v37
  v_fmac_f32 v46, v225, v38
  v_fmac_f32 v47, v225, v39
  s_waitcnt vmcnt(2)
  buffer_load_dwordx4 v[148:151], v5, s[32:35], s36 offen
  s_add_u32 s36, s36, 32768
  v_lshlrev_b32 v32, 16, v136
  v_and_b32 v33, s38, v136
  v_lshlrev_b32 v34, 16, v137
  v_and_b32 v35, s38, v137
  v_lshlrev_b32 v36, 16, v138
  v_and_b32 v37, s38, v138
  v_lshlrev_b32 v38, 16, v139
  v_and_b32 v39, s38, v139
  v_fmac_f32 v40, v226, v32
  v_fmac_f32 v41, v226, v33
  v_fmac_f32 v42, v226, v34
  v_fmac_f32 v43, v226, v35
  v_fmac_f32 v44, v226, v36
  v_fmac_f32 v45, v226, v37
  v_fmac_f32 v46, v226, v38
  v_fmac_f32 v47, v226, v39
  s_waitcnt vmcnt(2)
  buffer_load_dwordx4 v[152:155], v5, s[32:35], s36 offen
  s_add_u32 s36, s36, 32768
  v_lshlrev_b32 v32, 16, v140
  v_and_b32 v33, s38, v140
  v_lshlrev_b32 v34, 16, v141
  v_and_b32 v35, s38, v141
  v_lshlrev_b32 v36, 16, v142
  v_and_b32 v37, s38, v142
  v_lshlrev_b32 v38, 16, v143
  v_and_b32 v39, s38, v143
  v_fmac_f32 v40, v227, v32
  v_fmac_f32 v41, v227, v33
  v_fmac_f32 v42, v227, v34
  v_fmac_f32 v43, v227, v35
  v_fmac_f32 v44, v227, v36
  v_fmac_f32 v45, v227, v37
  v_fmac_f32 v46, v227, v38
  v_fmac_f32 v47, v227, v39
  s_waitcnt vmcnt(2)
  buffer_load_dwordx4 v[156:159], v5, s[32:35], s36 offen
  s_add_u32 s36, s36, 32768
  v_lshlrev_b32 v32, 16, v144
  v_and_b32 v33, s38, v144
  v_lshlrev_b32 v34, 16, v145
  v_and_b32 v35, s38, v145
  v_lshlrev_b32 v36, 16, v146
  v_and_b32 v37, s38, v146
  v_lshlrev_b32 v38, 16, v147
  v_and_b32 v39, s38, v147
  v_fmac_f32 v40, v228, v32
  v_fmac_f32 v41, v228, v33
  v_fmac_f32 v42, v228, v34
  v_fmac_f32 v43, v228, v35
  v_fmac_f32 v44, v228, v36
  v_fmac_f32 v45, v228, v37
  v_fmac_f32 v46, v228, v38
  v_fmac_f32 v47, v228, v39
  s_waitcnt vmcnt(2)
  buffer_load_dwordx4 v[160:163], v5, s[32:35], s36 offen
  s_add_u32 s36, s36, 32768
  v_lshlrev_b32 v32, 16, v148
  v_and_b32 v33, s38, v148
  v_lshlrev_b32 v34, 16, v149
  v_and_b32 v35, s38, v149
  v_lshlrev_b32 v36, 16, v150
  v_and_b32 v37, s38, v150
  v_lshlrev_b32 v38, 16, v151
  v_and_b32 v39, s38, v151
  v_fmac_f32 v40, v229, v32
  v_fmac_f32 v41, v229, v33
  v_fmac_f32 v42, v229, v34
  v_fmac_f32 v43, v229, v35
  v_fmac_f32 v44, v229, v36
  v_fmac_f32 v45, v229, v37
  v_fmac_f32 v46, v229, v38
  v_fmac_f32 v47, v229, v39
  s_waitcnt vmcnt(2)
  buffer_load_dwordx4 v[164:167], v5, s[32:35], s36 offen
  s_add_u32 s36, s36, 32768
  v_lshlrev_b32 v32, 16, v152
  v_and_b32 v33, s38, v152
  v_lshlrev_b32 v34, 16, v153
  v_and_b32 v35, s38, v153
  v_lshlrev_b32 v36, 16, v154
  v_and_b32 v37, s38, v154
  v_lshlrev_b32 v38, 16, v155
  v_and_b32 v39, s38, v155
  v_fmac_f32 v40, v230, v32
  v_fmac_f32 v41, v230, v33
  v_fmac_f32 v42, v230, v34
  v_fmac_f32 v43, v230, v35
  v_fmac_f32 v44, v230, v36
  v_fmac_f32 v45, v230, v37
  v_fmac_f32 v46, v230, v38
  v_fmac_f32 v47, v230, v39
  s_waitcnt vmcnt(2)
  buffer_load_dwordx4 v[168:171], v5, s[32:35], s36 offen
  s_add_u32 s36, s36, 32768
  v_lshlrev_b32 v32, 16, v156
  v_and_b32 v33, s38, v156
  v_lshlrev_b32 v34, 16, v157
  v_and_b32 v35, s38, v157
  v_lshlrev_b32 v36, 16, v158
  v_and_b32 v37, s38, v158
  v_lshlrev_b32 v38, 16, v159
  v_and_b32 v39, s38, v159
  v_fmac_f32 v40, v231, v32
  v_fmac_f32 v41, v231, v33
  v_fmac_f32 v42, v231, v34
  v_fmac_f32 v43, v231, v35
  v_fmac_f32 v44, v231, v36
  v_fmac_f32 v45, v231, v37
  v_fmac_f32 v46, v231, v38
  v_fmac_f32 v47, v231, v39
  s_waitcnt vmcnt(2)
  buffer_load_dwordx4 v[172:175], v5, s[32:35], s36 offen
  s_add_u32 s36, s36, 32768
  v_lshlrev_b32 v32, 16, v160
  v_and_b32 v33, s38, v160
  v_lshlrev_b32 v34, 16, v161
  v_and_b32 v35, s38, v161
  v_lshlrev_b32 v36, 16, v162
  v_and_b32 v37, s38, v162
  v_lshlrev_b32 v38, 16, v163
  v_and_b32 v39, s38, v163
  v_fmac_f32 v40, v232, v32
  v_fmac_f32 v41, v232, v33
  v_fmac_f32 v42, v232, v34
  v_fmac_f32 v43, v232, v35
  v_fmac_f32 v44, v232, v36
  v_fmac_f32 v45, v232, v37
  v_fmac_f32 v46, v232, v38
  v_fmac_f32 v47, v232, v39
  s_waitcnt vmcnt(2)
  buffer_load_dwordx4 v[176:179], v5, s[32:35], s36 offen
  s_add_u32 s36, s36, 32768
  v_lshlrev_b32 v32, 16, v164
  v_and_b32 v33, s38, v164
  v_lshlrev_b32 v34, 16, v165
  v_and_b32 v35, s38, v165
  v_lshlrev_b32 v36, 16, v166
  v_and_b32 v37, s38, v166
  v_lshlrev_b32 v38, 16, v167
  v_and_b32 v39, s38, v167
  v_fmac_f32 v40, v233, v32
  v_fmac_f32 v41, v233, v33
  v_fmac_f32 v42, v233, v34
  v_fmac_f32 v43, v233, v35
  v_fmac_f32 v44, v233, v36
  v_fmac_f32 v45, v233, v37
  v_fmac_f32 v46, v233, v38
  v_fmac_f32 v47, v233, v39
  s_waitcnt vmcnt(2)
  buffer_load_dwordx4 v[180:183], v5, s[32:35], s36 offen
  s_add_u32 s36, s36, 32768
  v_lshlrev_b32 v32, 16, v168
  v_and_b32 v33, s38, v168
  v_lshlrev_b32 v34, 16, v169
  v_and_b32 v35, s38, v169
  v_lshlrev_b32 v36, 16, v170
  v_and_b32 v37, s38, v170
  v_lshlrev_b32 v38, 16, v171
  v_and_b32 v39, s38, v171
  v_fmac_f32 v40, v234, v32
  v_fmac_f32 v41, v234, v33
  v_fmac_f32 v42, v234, v34
  v_fmac_f32 v43, v234, v35
  v_fmac_f32 v44, v234, v36
  v_fmac_f32 v45, v234, v37
  v_fmac_f32 v46, v234, v38
  v_fmac_f32 v47, v234, v39
  s_waitcnt vmcnt(2)
  buffer_load_dwordx4 v[184:187], v5, s[32:35], s36 offen
  s_add_u32 s36, s36, 32768
  v_lshlrev_b32 v32, 16, v172
  v_and_b32 v33, s38, v172
  v_lshlrev_b32 v34, 16, v173
  v_and_b32 v35, s38, v173
  v_lshlrev_b32 v36, 16, v174
  v_and_b32 v37, s38, v174
  v_lshlrev_b32 v38, 16, v175
  v_and_b32 v39, s38, v175
  v_fmac_f32 v40, v235, v32
  v_fmac_f32 v41, v235, v33
  v_fmac_f32 v42, v235, v34
  v_fmac_f32 v43, v235, v35
  v_fmac_f32 v44, v235, v36
  v_fmac_f32 v45, v235, v37
  v_fmac_f32 v46, v235, v38
  v_fmac_f32 v47, v235, v39
  s_waitcnt vmcnt(2)
  buffer_load_dwordx4 v[188:191], v5, s[32:35], s36 offen
  s_add_u32 s36, s36, 32768
  v_lshlrev_b32 v32, 16, v176
  v_and_b32 v33, s38, v176
  v_lshlrev_b32 v34, 16, v177
  v_and_b32 v35, s38, v177
  v_lshlrev_b32 v36, 16, v178
  v_and_b32 v37, s38, v178
  v_lshlrev_b32 v38, 16, v179
  v_and_b32 v39, s38, v179
  v_fmac_f32 v40, v236, v32
  v_fmac_f32 v41, v236, v33
  v_fmac_f32 v42, v236, v34
  v_fmac_f32 v43, v236, v35
  v_fmac_f32 v44, v236, v36
  v_fmac_f32 v45, v236, v37
  v_fmac_f32 v46, v236, v38
  v_fmac_f32 v47, v236, v39
  s_waitcnt vmcnt(2)
  buffer_load_dwordx4 v[192:195], v5, s[32:35], s36 offen
  s_add_u32 s36, s36, 32768
  v_lshlrev_b32 v32, 16, v180
  v_and_b32 v33, s38, v180
  v_lshlrev_b32 v34, 16, v181
  v_and_b32 v35, s38, v181
  v_lshlrev_b32 v36, 16, v182
  v_and_b32 v37, s38, v182
  v_lshlrev_b32 v38, 16, v183
  v_and_b32 v39, s38, v183
  v_fmac_f32 v40, v237, v32
  v_fmac_f32 v41, v237, v33
  v_fmac_f32 v42, v237, v34
  v_fmac_f32 v43, v237, v35
  v_fmac_f32 v44, v237, v36
  v_fmac_f32 v45, v237, v37
  v_fmac_f32 v46, v237, v38
  v_fmac_f32 v47, v237, v39
  s_waitcnt vmcnt(2)
  buffer_load_dwordx4 v[196:199], v5, s[32:35], s36 offen
  s_add_u32 s36, s36, 32768
  v_lshlrev_b32 v32, 16, v184
  v_and_b32 v33, s38, v184
  v_lshlrev_b32 v34, 16, v185
  v_and_b32 v35, s38, v185
  v_lshlrev_b32 v36, 16, v186
  v_and_b32 v37, s38, v186
  v_lshlrev_b32 v38, 16, v187
  v_and_b32 v39, s38, v187
  v_fmac_f32 v40, v238, v32
  v_fmac_f32 v41, v238, v33
  v_fmac_f32 v42, v238, v34
  v_fmac_f32 v43, v238, v35
  v_fmac_f32 v44, v238, v36
  v_fmac_f32 v45, v238, v37
  v_fmac_f32 v46, v238, v38
  v_fmac_f32 v47, v238, v39
  s_waitcnt vmcnt(2)
  buffer_load_dwordx4 v[200:203], v5, s[32:35], s36 offen
  s_add_u32 s36, s36, 32768
  v_lshlrev_b32 v32, 16, v188
  v_and_b32 v33, s38, v188
  v_lshlrev_b32 v34, 16, v189
  v_and_b32 v35, s38, v189
  v_lshlrev_b32 v36, 16, v190
  v_and_b32 v37, s38, v190
  v_lshlrev_b32 v38, 16, v191
  v_and_b32 v39, s38, v191
  v_fmac_f32 v40, v239, v32
  v_fmac_f32 v41, v239, v33
  v_fmac_f32 v42, v239, v34
  v_fmac_f32 v43, v239, v35
  v_fmac_f32 v44, v239, v36
  v_fmac_f32 v45, v239, v37
  v_fmac_f32 v46, v239, v38
  v_fmac_f32 v47, v239, v39
  s_waitcnt vmcnt(2)
  buffer_load_dwordx4 v[204:207], v5, s[32:35], s36 offen
  s_add_u32 s36, s36, 32768
  v_lshlrev_b32 v32, 16, v192
  v_and_b32 v33, s38, v192
  v_lshlrev_b32 v34, 16, v193
  v_and_b32 v35, s38, v193
  v_lshlrev_b32 v36, 16, v194
  v_and_b32 v37, s38, v194
  v_lshlrev_b32 v38, 16, v195
  v_and_b32 v39, s38, v195
  v_fmac_f32 v40, v240, v32
  v_fmac_f32 v41, v240, v33
  v_fmac_f32 v42, v240, v34
  v_fmac_f32 v43, v240, v35
  v_fmac_f32 v44, v240, v36
  v_fmac_f32 v45, v240, v37
  v_fmac_f32 v46, v240, v38
  v_fmac_f32 v47, v240, v39
  s_waitcnt vmcnt(2)
  v_lshlrev_b32 v32, 16, v196
  v_and_b32 v33, s38, v196
  v_lshlrev_b32 v34, 16, v197
  v_and_b32 v35, s38, v197
  v_lshlrev_b32 v36, 16, v198
  v_and_b32 v37, s38, v198
  v_lshlrev_b32 v38, 16, v199
  v_and_b32 v39, s38, v199
  v_fmac_f32 v40, v241, v32
  v_fmac_f32 v41, v241, v33
  v_fmac_f32 v42, v241, v34
  v_fmac_f32 v43, v241, v35
  v_fmac_f32 v44, v241, v36
  v_fmac_f32 v45, v241, v37
  v_fmac_f32 v46, v241, v38
  v_fmac_f32 v47, v241, v39
  s_waitcnt vmcnt(1)
  v_lshlrev_b32 v32, 16, v200
  v_and_b32 v33, s38, v200
  v_lshlrev_b32 v34, 16, v201
  v_and_b32 v35, s38, v201
  v_lshlrev_b32 v36, 16, v202
  v_and_b32 v37, s38, v202
  v_lshlrev_b32 v38, 16, v203
  v_and_b32 v39, s38, v203
  v_fmac_f32 v40, v242, v32
  v_fmac_f32 v41, v242, v33
  v_fmac_f32 v42, v242, v34
  v_fmac_f32 v43, v242, v35
  v_fmac_f32 v44, v242, v36
  v_fmac_f32 v45, v242, v37
  v_fmac_f32 v46, v242, v38
  v_fmac_f32 v47, v242, v39
  s_waitcnt vmcnt(0)
  v_lshlrev_b32 v32, 16, v204
  v_and_b32 v33, s38, v204
  v_lshlrev_b32 v34, 16, v205
  v_and_b32 v35, s38, v205
  v_lshlrev_b32 v36, 16, v206
  v_and_b32 v37, s38, v206
  v_lshlrev_b32 v38, 16, v207
  v_and_b32 v39, s38, v207
  v_fmac_f32 v40, v243, v32
  v_fmac_f32 v41, v243, v33
  v_fmac_f32 v42, v243, v34
  v_fmac_f32 v43, v243, v35
  v_fmac_f32 v44, v243, v36
  v_fmac_f32 v45, v243, v37
  v_fmac_f32 v46, v243, v38
  v_fmac_f32 v47, v243, v39
  v_permlane32_swap_b32 v40, v44
  v_permlane32_swap_b32 v41, v45
  v_permlane32_swap_b32 v42, v46
  v_permlane32_swap_b32 v43, v47
  v_add_f32 v40, v40, v44
  v_add_f32 v41, v41, v45
  v_add_f32 v42, v42, v46
  v_add_f32 v43, v43, v47
  s_nop 0
  v_permlane16_swap_b32 v40, v42
  v_permlane16_swap_b32 v41, v43
  v_add_f32 v40, v40, v42
  v_add_f32 v41, v41, v43
  v_lshlrev_b32 v6, 5, v3
  v_lshl_add_u32 v6, v2, 3, v6
  s_lshl_b32 s50, s64, 9
  v_add_u32 v6, s50, v6
  ds_write_b64 v6, v[40:41] offset:4608
  s_waitcnt lgkmcnt(0)
  v_mov_b32 v6, 0
  v_mov_b32 v7, 1
  s_mov_b64 exec, 1
  ds_add_u32 v6, v7 offset:6720
  s_mov_b64 exec, -1
  s_cmp_lg_u32 s64, 3
  s_cbranch_scc1 L_noclear
  s_cmp_ge_u32 s45, 18
  s_cbranch_scc1 L_noclear
  s_mul_i32 s50, s31, 18
  s_add_u32 s50, s50, s45
  s_lshl_b32 s50, s50, 12
  s_add_u32 s40, s28, s50
  s_addc_u32 s41, s29, 0
  s_and_b32 s41, s41, 0xffff
  s_mov_b32 s42, 4096
  s_mov_b32 s43, 0x20000
  v_lshlrev_b32 v6, 4, v1
  v_mov_b32 v32, -1
  v_mov_b32 v33, -1
  v_mov_b32 v34, -1
  v_mov_b32 v35, -1
  buffer_store_dwordx4 v[32:35], v6, s[40:43], 0 offen offset:0 sc1
  buffer_store_dwordx4 v[32:35], v6, s[40:43], 0 offen offset:1024 sc1
  buffer_store_dwordx4 v[32:35], v6, s[40:43], 0 offen offset:2048 sc1
  buffer_store_dwordx4 v[32:35], v6, s[40:43], 0 offen offset:3072 sc1
  s_lshl_b32 s50, s31, 2
  s_add_u32 s50, s50, 32
  v_mov_b32 v6, s50
  s_waitcnt vmcnt(0)
  s_mov_b64 exec, 1
  global_atomic_add v6, v7, s[26:27]
  s_mov_b64 exec, -1
L_noclear:
  v_mov_b32 v40, 0
  v_mov_b32 v48, 0
  v_mov_b32 v41, 0
  v_mov_b32 v49, 0
  v_mov_b32 v42, 0
  v_mov_b32 v50, 0
  v_mov_b32 v43, 0
  v_mov_b32 v51, 0
  v_mov_b32 v44, 0
  v_mov_b32 v52, 0
  v_mov_b32 v45, 0
  v_mov_b32 v53, 0
  v_mov_b32 v46, 0
  v_mov_b32 v54, 0
  v_mov_b32 v47, 0
  v_mov_b32 v55, 0
  v_lshrrev_b32 v8, 3, v1
  v_and_b32 v9, 7, v1
  s_lshr_b32 s50, s39, 2
  s_mul_i32 s50, s50, 9
  s_and_b32 s51, s39, 3
  s_lshl_b32 s65, s51, 1
  s_add_u32 s65, s65, s50
  s_cmp_eq_u32 s51, 3
  s_cselect_b32 s50, 3, 2
  s_add_u32 s65, s65, s64
  s_cmp_ge_u32 s64, s50
  s_cbranch_scc1 L_nomlp
  v_add_f32 v32, v20, v21
  v_add_f32 v32, v32, v22
  v_add_f32 v32, v32, v23
  v_add_f32 v32, v32, v24
  v_add_f32 v32, v32, v25
  v_add_f32 v32, v32, v26
  v_add_f32 v32, v32, v27
  v_add_f32 v32, v32, v28
  s_nop 1
  v_add_f32_dpp v32, v32, v32 row_ror:8 row_mask:0xf bank_mask:0xf
  s_nop 1
  v_add_f32_dpp v32, v32, v32 row_ror:4 row_mask:0xf bank_mask:0xf
  s_nop 1
  v_add_f32_dpp v32, v32, v32 row_ror:2 row_mask:0xf bank_mask:0xf
  s_nop 1
  v_add_f32_dpp v32, v32, v32 row_ror:1 row_mask:0xf bank_mask:0xf
  v_mov_b32 v33, v32
  s_nop 1
  v_permlane16_swap_b32 v32, v33
  v_add_f32 v32, v32, v33
  v_mov_b32 v33, v32
  s_nop 1
  v_permlane32_swap_b32 v32, v33
  v_add_f32 v32, v32, v33
  v_mov_b32 v39, 0x44100000
  v_rcp_f32 v36, v39
  s_nop 0
  v_mul_f32 v34, v32, v36
  v_fma_f32 v37, -v34, v39, v32
  v_fma_f32 v34, v37, v36, v34
  v_mov_b32 v35, v34
  v_cvt_pk_bf16_f32 v35, v35, v35
  v_and_b32 v35, s38, v35
  v_sub_f32 v100, v20, v34
  v_sub_f32 v101, v21, v34
  v_sub_f32 v102, v22, v34
  v_sub_f32 v103, v23, v34
  v_sub_f32 v104, v24, v34
  v_sub_f32 v105, v25, v34
  v_sub_f32 v106, v26, v34
  v_sub_f32 v107, v27, v34
  v_sub_f32 v108, v28, v34
  v_mul_f32 v32, v100, v100
  v_fmac_f32 v32, v101, v101
  v_fmac_f32 v32, v102, v102
  v_fmac_f32 v32, v103, v103
  v_fmac_f32 v32, v104, v104
  v_fmac_f32 v32, v105, v105
  v_fmac_f32 v32, v106, v106
  v_fmac_f32 v32, v107, v107
  v_fmac_f32 v32, v108, v108
  s_nop 1
  v_add_f32_dpp v32, v32, v32 row_ror:8 row_mask:0xf bank_mask:0xf
  s_nop 1
  v_add_f32_dpp v32, v32, v32 row_ror:4 row_mask:0xf bank_mask:0xf
  s_nop 1
  v_add_f32_dpp v32, v32, v32 row_ror:2 row_mask:0xf bank_mask:0xf
  s_nop 1
  v_add_f32_dpp v32, v32, v32 row_ror:1 row_mask:0xf bank_mask:0xf
  v_mov_b32 v33, v32
  s_nop 1
  v_permlane16_swap_b32 v32, v33
  v_add_f32 v32, v32, v33
  v_mov_b32 v33, v32
  s_nop 1
  v_permlane32_swap_b32 v32, v33
  v_add_f32 v32, v32, v33
  v_mul_f32 v38, v32, v36
  v_fma_f32 v37, -v38, v39, v32
  v_fma_f32 v38, v37, v36, v38
  v_cvt_pk_bf16_f32 v38, v38, v38
  v_and_b32 v38, s38, v38
  v_add_f32 v38, 0x3727c5ac, v38
  v_cvt_pk_bf16_f32 v38, v38, v38
  v_and_b32 v38, s38, v38
  v_sqrt_f32 v38, v38
  s_nop 0
  v_cvt_pk_bf16_f32 v38, v38, v38
  v_and_b32 v38, s38, v38
  v_rcp_f32 v36, v38
  v_sub_f32 v100, v20, v35
  v_cvt_pk_bf16_f32 v100, v100, v100
  v_and_b32 v100, s38, v100
  v_mov_b32 v33, v100
  v_mul_f32 v100, v33, v36
  v_fma_f32 v37, -v100, v38, v33
  v_fma_f32 v100, v37, v36, v100
  v_cvt_pk_bf16_f32 v100, v100, v100
  v_and_b32 v100, s38, v100
  v_sub_f32 v101, v21, v35
  v_cvt_pk_bf16_f32 v101, v101, v101
  v_and_b32 v101, s38, v101
  v_mov_b32 v33, v101
  v_mul_f32 v101, v33, v36
  v_fma_f32 v37, -v101, v38, v33
  v_fma_f32 v101, v37, v36, v101
  v_cvt_pk_bf16_f32 v101, v101, v101
  v_and_b32 v101, s38, v101
  v_sub_f32 v102, v22, v35
  v_cvt_pk_bf16_f32 v102, v102, v102
  v_and_b32 v102, s38, v102
  v_mov_b32 v33, v102
  v_mul_f32 v102, v33, v36
  v_fma_f32 v37, -v102, v38, v33
  v_fma_f32 v102, v37, v36, v102
  v_cvt_pk_bf16_f32 v102, v102, v102
  v_and_b32 v102, s38, v102
  v_sub_f32 v103, v23, v35
  v_cvt_pk_bf16_f32 v103, v103, v103
  v_and_b32 v103, s38, v103
  v_mov_b32 v33, v103
  v_mul_f32 v103, v33, v36
  v_fma_f32 v37, -v103, v38, v33
  v_fma_f32 v103, v37, v36, v103
  v_cvt_pk_bf16_f32 v103, v103, v103
  v_and_b32 v103, s38, v103
  v_sub_f32 v104, v24, v35
  v_cvt_pk_bf16_f32 v104, v104, v104
  v_and_b32 v104, s38, v104
  v_mov_b32 v33, v104
  v_mul_f32 v104, v33, v36
  v_fma_f32 v37, -v104, v38, v33
  v_fma_f32 v104, v37, v36, v104
  v_cvt_pk_bf16_f32 v104, v104, v104
  v_and_b32 v104, s38, v104
  v_sub_f32 v105, v25, v35
  v_cvt_pk_bf16_f32 v105, v105, v105
  v_and_b32 v105, s38, v105
  v_mov_b32 v33, v105
  v_mul_f32 v105, v33, v36
  v_fma_f32 v37, -v105, v38, v33
  v_fma_f32 v105, v37, v36, v105
  v_cvt_pk_bf16_f32 v105, v105, v105
  v_and_b32 v105, s38, v105
  v_sub_f32 v106, v26, v35
  v_cvt_pk_bf16_f32 v106, v106, v106
  v_and_b32 v106, s38, v106
  v_mov_b32 v33, v106
  v_mul_f32 v106, v33, v36
  v_fma_f32 v37, -v106, v38, v33
  v_fma_f32 v106, v37, v36, v106
  v_cvt_pk_bf16_f32 v106, v106, v106
  v_and_b32 v106, s38, v106
  v_sub_f32 v107, v27, v35
  v_cvt_pk_bf16_f32 v107, v107, v107
  v_and_b32 v107, s38, v107
  v_mov_b32 v33, v107
  v_mul_f32 v107, v33, v36
  v_fma_f32 v37, -v107, v38, v33
  v_fma_f32 v107, v37, v36, v107
  v_cvt_pk_bf16_f32 v107, v107, v107
  v_and_b32 v107, s38, v107
  v_sub_f32 v108, v28, v35
  v_cvt_pk_bf16_f32 v108, v108, v108
  v_and_b32 v108, s38, v108
  v_mov_b32 v33, v108
  v_mul_f32 v108, v33, v36
  v_fma_f32 v37, -v108, v38, v33
  v_fma_f32 v108, v37, v36, v108
  v_cvt_pk_bf16_f32 v108, v108, v108
  v_and_b32 v108, s38, v108
  v_lshlrev_b32 v6, 2, v1
  ds_write_b32 v6, v100 offset:2304
  ds_write_b32 v6, v101 offset:2560
  ds_write_b32 v6, v102 offset:2816
  ds_write_b32 v6, v103 offset:3072
  ds_write_b32 v6, v104 offset:3328
  ds_write_b32 v6, v105 offset:3584
  ds_write_b32 v6, v106 offset:3840
  ds_write_b32 v6, v107 offset:4096
  ds_write_b32 v6, v108 offset:4352
  v_mul_u32_u24 v10, 9216, v8
  v_lshl_add_u32 v10, v9, 4, v10
  s_lshl_b32 s50, s65, 7
  v_add_u32 v10, s50, v10
  s_mov_b32 s32, s16
  s_and_b32 s33, s17, 0xffff
  s_mov_b32 s34, 5308416
  s_mov_b32 s35, 0x20000
  s_mov_b32 s40, s18
  s_and_b32 s41, s19, 0xffff
  s_mov_b32 s42, 9216
  s_mov_b32 s43, 0x20000
  v_lshlrev_b32 v12, 4, v9
  v_lshl_add_u32 v12, v2, 2, v12
  v_add_u32 v12, s50, v12
  buffer_load_dword v13, v12, s[40:43], 0 offen
  v_lshlrev_b32 v14, 2, v8
  s_mul_i32 s36, s31, 589824
  s_mov_b32 s59, s31
  buffer_load_dwordx4 v[64:67], v10, s[32:35], s36 offen
  s_add_u32 s36, s36, 73728
  buffer_load_dwordx4 v[68:71], v10, s[32:35], s36 offen
  s_add_u32 s36, s36, 73728
  s_waitcnt lgkmcnt(0)
  s_mov_b32 s37, 9
L_mlp1:
  s_lshl_b32 s58, s59, 8
  v_add_u32 v15, s58, v14
  s_add_u32 s59, s59, 1
  s_cmp_eq_u32 s59, 9
  s_cselect_b32 s59, 0, s59
  ds_read_b32 v100, v15 offset:2304
  ds_read_b32 v101, v15 offset:2336
  ds_read_b32 v102, v15 offset:2368
  ds_read_b32 v103, v15 offset:2400
  ds_read_b32 v104, v15 offset:2432
  ds_read_b32 v105, v15 offset:2464
  ds_read_b32 v106, v15 offset:2496
  ds_read_b32 v107, v15 offset:2528
  s_waitcnt lgkmcnt(0)
  s_waitcnt vmcnt(1)
  buffer_load_dwordx4 v[72:75], v10, s[32:35], s36 offen
  s_add_u32 s36, s36, 73728
  v_lshlrev_b32 v32, 16, v64
  v_and_b32 v33, s38, v64
  v_lshlrev_b32 v34, 16, v65
  v_and_b32 v35, s38, v65
  v_lshlrev_b32 v36, 16, v66
  v_and_b32 v37, s38, v66
  v_lshlrev_b32 v38, 16, v67
  v_and_b32 v39, s38, v67
  v_fmac_f32 v40, v100, v32
  v_fmac_f32 v41, v100, v33
  v_fmac_f32 v42, v100, v34
  v_fmac_f32 v43, v100, v35
  v_fmac_f32 v44, v100, v36
  v_fmac_f32 v45, v100, v37
  v_fmac_f32 v46, v100, v38
  v_fmac_f32 v47, v100, v39
  s_waitcnt vmcnt(1)
  buffer_load_dwordx4 v[76:79], v10, s[32:35], s36 offen
  s_add_u32 s36, s36, 73728
  v_lshlrev_b32 v32, 16, v68
  v_and_b32 v33, s38, v68
  v_lshlrev_b32 v34, 16, v69
  v_and_b32 v35, s38, v69
  v_lshlrev_b32 v36, 16, v70
  v_and_b32 v37, s38, v70
  v_lshlrev_b32 v38, 16, v71
  v_and_b32 v39, s38, v71
  v_fmac_f32 v40, v101, v32
  v_fmac_f32 v41, v101, v33
  v_fmac_f32 v42, v101, v34
  v_fmac_f32 v43, v101, v35
  v_fmac_f32 v44, v101, v36
  v_fmac_f32 v45, v101, v37
  v_fmac_f32 v46, v101, v38
  v_fmac_f32 v47, v101, v39
  s_waitcnt vmcnt(1)
  buffer_load_dwordx4 v[80:83], v10, s[32:35], s36 offen
  s_add_u32 s36, s36, 73728
  v_lshlrev_b32 v32, 16, v72
  v_and_b32 v33, s38, v72
  v_lshlrev_b32 v34, 16, v73
  v_and_b32 v35, s38, v73
  v_lshlrev_b32 v36, 16, v74
  v_and_b32 v37, s38, v74
  v_lshlrev_b32 v38, 16, v75
  v_and_b32 v39, s38, v75
  v_fmac_f32 v40, v102, v32
  v_fmac_f32 v41, v102, v33
  v_fmac_f32 v42, v102, v34
  v_fmac_f32 v43, v102, v35
  v_fmac_f32 v44, v102, v36
  v_fmac_f32 v45, v102, v37
  v_fmac_f32 v46, v102, v38
  v_fmac_f32 v47, v102, v39
  s_waitcnt vmcnt(1)
  buffer_load_dwordx4 v[84:87], v10, s[32:35], s36 offen
  s_add_u32 s36, s36, 73728
  v_lshlrev_b32 v32, 16, v76
  v_and_b32 v33, s38, v76
  v_lshlrev_b32 v34, 16, v77
  v_and_b32 v35, s38, v77
  v_lshlrev_b32 v36, 16, v78
  v_and_b32 v37, s38, v78
  v_lshlrev_b32 v38, 16, v79
  v_and_b32 v39, s38, v79
  v_fmac_f32 v40, v103, v32
  v_fmac_f32 v41, v103, v33
  v_fmac_f32 v42, v103, v34
  v_fmac_f32 v43, v103, v35
  v_fmac_f32 v44, v103, v36
  v_fmac_f32 v45, v103, v37
  v_fmac_f32 v46, v103, v38
  v_fmac_f32 v47, v103, v39
  s_waitcnt vmcnt(1)
  buffer_load_dwordx4 v[88:91], v10, s[32:35], s36 offen
  s_add_u32 s36, s36, 73728
  v_lshlrev_b32 v32, 16, v80
  v_and_b32 v33, s38, v80
  v_lshlrev_b32 v34, 16, v81
  v_and_b32 v35, s38, v81
  v_lshlrev_b32 v36, 16, v82
  v_and_b32 v37, s38, v82
  v_lshlrev_b32 v38, 16, v83
  v_and_b32 v39, s38, v83
  v_fmac_f32 v40, v104, v32
  v_fmac_f32 v41, v104, v33
  v_fmac_f32 v42, v104, v34
  v_fmac_f32 v43, v104, v35
  v_fmac_f32 v44, v104, v36
  v_fmac_f32 v45, v104, v37
  v_fmac_f32 v46, v104, v38
  v_fmac_f32 v47, v104, v39
  s_waitcnt vmcnt(1)
  buffer_load_dwordx4 v[92:95], v10, s[32:35], s36 offen
  s_add_u32 s36, s36, 73728
  v_lshlrev_b32 v32, 16, v84
  v_and_b32 v33, s38, v84
  v_lshlrev_b32 v34, 16, v85
  v_and_b32 v35, s38, v85
  v_lshlrev_b32 v36, 16, v86
  v_and_b32 v37, s38, v86
  v_lshlrev_b32 v38, 16, v87
  v_and_b32 v39, s38, v87
  v_fmac_f32 v40, v105, v32
  v_fmac_f32 v41, v105, v33
  v_fmac_f32 v42, v105, v34
  v_fmac_f32 v43, v105, v35
  v_fmac_f32 v44, v105, v36
  v_fmac_f32 v45, v105, v37
  v_fmac_f32 v46, v105, v38
  v_fmac_f32 v47, v105, v39
  s_waitcnt vmcnt(1)
  s_cmp_eq_u32 s36, 5308416
  s_cselect_b32 s36, 0, s36
  buffer_load_dwordx4 v[64:67], v10, s[32:35], s36 offen
  s_add_u32 s36, s36, 73728
  v_lshlrev_b32 v32, 16, v88
  v_and_b32 v33, s38, v88
  v_lshlrev_b32 v34, 16, v89
  v_and_b32 v35, s38, v89
  v_lshlrev_b32 v36, 16, v90
  v_and_b32 v37, s38, v90
  v_lshlrev_b32 v38, 16, v91
  v_and_b32 v39, s38, v91
  v_fmac_f32 v40, v106, v32
  v_fmac_f32 v41, v106, v33
  v_fmac_f32 v42, v106, v34
  v_fmac_f32 v43, v106, v35
  v_fmac_f32 v44, v106, v36
  v_fmac_f32 v45, v106, v37
  v_fmac_f32 v46, v106, v38
  v_fmac_f32 v47, v106, v39
  s_waitcnt vmcnt(1)
  buffer_load_dwordx4 v[68:71], v10, s[32:35], s36 offen
  s_add_u32 s36, s36, 73728
  v_lshlrev_b32 v32, 16, v92
  v_and_b32 v33, s38, v92
  v_lshlrev_b32 v34, 16, v93
  v_and_b32 v35, s38, v93
  v_lshlrev_b32 v36, 16, v94
  v_and_b32 v37, s38, v94
  v_lshlrev_b32 v38, 16, v95
  v_and_b32 v39, s38, v95
  v_fmac_f32 v40, v107, v32
  v_fmac_f32 v41, v107, v33
  v_fmac_f32 v42, v107, v34
  v_fmac_f32 v43, v107, v35
  v_fmac_f32 v44, v107, v36
  v_fmac_f32 v45, v107, v37
  v_fmac_f32 v46, v107, v38
  v_fmac_f32 v47, v107, v39
  s_sub_u32 s37, s37, 1
  s_cmp_lg_u32 s37, 0
  s_cbranch_scc1 L_mlp1
  v_permlane32_swap_b32 v40, v44
  v_permlane32_swap_b32 v41, v45
  v_permlane32_swap_b32 v42, v46
  v_permlane32_swap_b32 v43, v47
  v_add_f32 v40, v40, v44
  v_add_f32 v41, v41, v45
  v_add_f32 v42, v42, v46
  v_add_f32 v43, v43, v47
  s_nop 0
  v_permlane16_swap_b32 v40, v42
  v_permlane16_swap_b32 v41, v43
  v_add_f32 v40, v40, v42
  v_add_f32 v41, v41, v43
  s_nop 0
  v_add_f32_dpp v40, v40, v40 row_ror:8 row_mask:0xf bank_mask:0xf
  v_add_f32_dpp v41, v41, v41 row_ror:8 row_mask:0xf bank_mask:0xf
  s_waitcnt vmcnt(0)
  v_lshlrev_b32 v38, 16, v13
  v_and_b32 v39, s38, v13
  v_cvt_pk_bf16_f32 v40, v40, v40
  v_and_b32 v40, s38, v40
  v_add_f32 v40, v40, v38
  v_cvt_pk_bf16_f32 v40, v40, v40
  v_and_b32 v40, s38, v40
  v_mul_f32 v33, v40, v40
  v_mov_b32 v34, 0x3d372713
  v_fma_f32 v33, v33, v34, 1.0
  v_mul_f32 v33, v33, v40
  v_mul_f32 v33, 0xc0135761, v33
  v_exp_f32 v33, v33
  s_nop 0
  v_add_f32 v33, 1.0, v33
  v_rcp_f32 v33, v33
  s_nop 0
  v_mul_f32 v40, v40, v33
  v_cvt_pk_bf16_f32 v41, v41, v41
  v_and_b32 v41, s38, v41
  v_add_f32 v41, v41, v39
  v_cvt_pk_bf16_f32 v41, v41, v41
  v_and_b32 v41, s38, v41
  v_mul_f32 v33, v41, v41
  v_mov_b32 v34, 0x3d372713
  v_fma_f32 v33, v33, v34, 1.0
  v_mul_f32 v33, v33, v41
  v_mul_f32 v33, 0xc0135761, v33
  v_exp_f32 v33, v33
  s_nop 0
  v_add_f32 v33, 1.0, v33
  v_rcp_f32 v33, v33
  s_nop 0
  v_mul_f32 v41, v41, v33
  v_cvt_pk_bf16_f32 v56, v40, v41
  v_mov_b32 v40, 0
  v_mov_b32 v41, 0
  v_mov_b32 v42, 0
  v_mov_b32 v43, 0
  v_mov_b32 v44, 0
  v_mov_b32 v45, 0
  v_mov_b32 v46, 0
  v_mov_b32 v47, 0
  s_mul_i32 s50, s65, 73728
  v_lshlrev_b32 v10, 4, v1
  v_add_u32 v10, s50, v10
  v_mul_u32_u24 v11, 2304, v8
  v_lshl_add_u32 v11, v9, 4, v11
  v_add_u32 v11, 1024, v11
  v_add_u32 v11, s50, v11
  s_mov_b32 s32, s20
  s_and_b32 s33, s21, 0xffff
  s_mov_b32 s34, 5308416
  s_mov_b32 s35, 0x20000
  s_mov_b32 s56, 0x05040100
  s_mov_b32 s57, 0x07060302
  v_and_b32 v12, 3, v8
  v_lshlrev_b32 v12, 4, v12
  v_lshrrev_b32 v13, 2, v8
  v_add_u32 v12, v12, v13
  v_lshlrev_b32 v12, 2, v12
  v_add_u32 v13, 0, v12
  ds_bpermute_b32 v16, v13, v56
  v_add_u32 v13, 8, v12
  ds_bpermute_b32 v17, v13, v56
  v_add_u32 v13, 16, v12
  ds_bpermute_b32 v18, v13, v56
  v_add_u32 v13, 24, v12
  ds_bpermute_b32 v19, v13, v56
  s_mul_i32 s36, s31, 9216
  s_mov_b32 s59, s31
  buffer_load_dwordx4 v[64:67], v10, s[32:35], s36 offen
  s_addk_i32 s36, 1152
  buffer_load_dwordx4 v[68:71], v10, s[32:35], s36 offen
  s_addk_i32 s36, 1152
  buffer_load_dwordx4 v[72:75], v10, s[32:35], s36 offen
  s_addk_i32 s36, 1152
  s_mov_b32 s37, 7
L_mlp2:
  s_add_u32 s54, s59, 0
  v_readlane_b32 s55, v56, s54
  s_waitcnt vmcnt(2)
  buffer_load_dwordx4 v[76:79], v10, s[32:35], s36 offen
  s_addk_i32 s36, 1152
  s_waitcnt vmcnt(2)
  buffer_load_dwordx4 v[80:83], v10, s[32:35], s36 offen
  s_addk_i32 s36, 1152
  v_perm_b32 v32, v68, v64, s56
  v_perm_b32 v33, v68, v64, s57
  v_perm_b32 v34, v69, v65, s56
  v_perm_b32 v35, v69, v65, s57
  v_perm_b32 v36, v70, v66, s56
  v_perm_b32 v37, v70, v66, s57
  v_perm_b32 v38, v71, v67, s56
  v_perm_b32 v39, v71, v67, s57
  v_dot2_f32_bf16 v40, v32, s55, v40
  v_dot2_f32_bf16 v41, v33, s55, v41
  v_dot2_f32_bf16 v42, v34, s55, v42
  v_dot2_f32_bf16 v43, v35, s55, v43
  v_dot2_f32_bf16 v44, v36, s55, v44
  v_dot2_f32_bf16 v45, v37, s55, v45
  v_dot2_f32_bf16 v46, v38, s55, v46
  v_dot2_f32_bf16 v47, v39, s55, v47
  s_add_u32 s54, s59, 16
  v_readlane_b32 s55, v56, s54
  s_waitcnt vmcnt(2)
  buffer_load_dwordx4 v[84:87], v10, s[32:35], s36 offen
  s_addk_i32 s36, 1152
  s_waitcnt vmcnt(2)
  buffer_load_dwordx4 v[88:91], v10, s[32:35], s36 offen
  s_addk_i32 s36, 1152
  v_perm_b32 v32, v76, v72, s56
  v_perm_b32 v33, v76, v72, s57
  v_perm_b32 v34, v77, v73, s56
  v_perm_b32 v35, v77, v73, s57
  v_perm_b32 v36, v78, v74, s56
  v_perm_b32 v37, v78, v74, s57
  v_perm_b32 v38, v79, v75, s56
  v_perm_b32 v39, v79, v75, s57
  v_dot2_f32_bf16 v40, v32, s55, v40
  v_dot2_f32_bf16 v41, v33, s55, v41
  v_dot2_f32_bf16 v42, v34, s55, v42
  v_dot2_f32_bf16 v43, v35, s55, v43
  v_dot2_f32_bf16 v44, v36, s55, v44
  v_dot2_f32_bf16 v45, v37, s55, v45
  v_dot2_f32_bf16 v46, v38, s55, v46
  v_dot2_f32_bf16 v47, v39, s55, v47
  s_add_u32 s54, s59, 32
  v_readlane_b32 s55, v56, s54
  s_waitcnt vmcnt(2)
  buffer_load_dwordx4 v[92:95], v10, s[32:35], s36 offen
  s_addk_i32 s36, 1152
  s_waitcnt vmcnt(2)
  s_cmp_eq_u32 s36, 73728
  s_cselect_b32 s36, 0, s36
  buffer_load_dwordx4 v[64:67], v10, s[32:35], s36 offen
  s_addk_i32 s36, 1152
  v_perm_b32 v32, v84, v80, s56
  v_perm_b32 v33, v84, v80, s57
  v_perm_b32 v34, v85, v81, s56
  v_perm_b32 v35, v85, v81, s57
  v_perm_b32 v36, v86, v82, s56
  v_perm_b32 v37, v86, v82, s57
  v_perm_b32 v38, v87, v83, s56
  v_perm_b32 v39, v87, v83, s57
  v_dot2_f32_bf16 v40, v32, s55, v40
  v_dot2_f32_bf16 v41, v33, s55, v41
  v_dot2_f32_bf16 v42, v34, s55, v42
  v_dot2_f32_bf16 v43, v35, s55, v43
  v_dot2_f32_bf16 v44, v36, s55, v44
  v_dot2_f32_bf16 v45, v37, s55, v45
  v_dot2_f32_bf16 v46, v38, s55, v46
  v_dot2_f32_bf16 v47, v39, s55, v47
  s_add_u32 s54, s59, 48
  v_readlane_b32 s55, v56, s54
  s_waitcnt vmcnt(2)
  buffer_load_dwordx4 v[68:71], v10, s[32:35], s36 offen
  s_addk_i32 s36, 1152
  s_waitcnt vmcnt(2)
  buffer_load_dwordx4 v[72:75], v10, s[32:35], s36 offen
  s_addk_i32 s36, 1152
  v_perm_b32 v32, v92, v88, s56
  v_perm_b32 v33, v92, v88, s57
  v_perm_b32 v34, v93, v89, s56
  v_perm_b32 v35, v93, v89, s57
  v_perm_b32 v36, v94, v90, s56
  v_perm_b32 v37, v94, v90, s57
  v_perm_b32 v38, v95, v91, s56
  v_perm_b32 v39, v95, v91, s57
  v_dot2_f32_bf16 v40, v32, s55, v40
  v_dot2_f32_bf16 v41, v33, s55, v41
  v_dot2_f32_bf16 v42, v34, s55, v42
  v_dot2_f32_bf16 v43, v35, s55, v43
  v_dot2_f32_bf16 v44, v36, s55, v44
  v_dot2_f32_bf16 v45, v37, s55, v45
  v_dot2_f32_bf16 v46, v38, s55, v46
  v_dot2_f32_bf16 v47, v39, s55, v47
  s_add_u32 s59, s59, 1
  s_and_b32 s59, s59, 7
  s_sub_u32 s37, s37, 1
  s_cmp_lg_u32 s37, 0
  s_cbranch_scc1 L_mlp2
  s_add_u32 s54, s59, 0
  v_readlane_b32 s55, v56, s54
  s_waitcnt vmcnt(2)
  buffer_load_dwordx4 v[76:79], v10, s[32:35], s36 offen
  s_addk_i32 s36, 1152
  s_waitcnt vmcnt(2)
  buffer_load_dwordx4 v[80:83], v10, s[32:35], s36 offen
  s_addk_i32 s36, 1152
  v_perm_b32 v32, v68, v64, s56
  v_perm_b32 v33, v68, v64, s57
  v_perm_b32 v34, v69, v65, s56
  v_perm_b32 v35, v69, v65, s57
  v_perm_b32 v36, v70, v66, s56
  v_perm_b32 v37, v70, v66, s57
  v_perm_b32 v38, v71, v67, s56
  v_perm_b32 v39, v71, v67, s57
  v_dot2_f32_bf16 v40, v32, s55, v40
  v_dot2_f32_bf16 v41, v33, s55, v41
  v_dot2_f32_bf16 v42, v34, s55, v42
  v_dot2_f32_bf16 v43, v35, s55, v43
  v_dot2_f32_bf16 v44, v36, s55, v44
  v_dot2_f32_bf16 v45, v37, s55, v45
  v_dot2_f32_bf16 v46, v38, s55, v46
  v_dot2_f32_bf16 v47, v39, s55, v47
  s_add_u32 s54, s59, 16
  v_readlane_b32 s55, v56, s54
  s_waitcnt vmcnt(2)
  buffer_load_dwordx4 v[84:87], v10, s[32:35], s36 offen
  s_addk_i32 s36, 1152
  s_waitcnt vmcnt(2)
  buffer_load_dwordx4 v[88:91], v10, s[32:35], s36 offen
  s_addk_i32 s36, 1152
  v_perm_b32 v32, v76, v72, s56
  v_perm_b32 v33, v76, v72, s57
  v_perm_b32 v34, v77, v73, s56
  v_perm_b32 v35, v77, v73, s57
  v_perm_b32 v36, v78, v74, s56
  v_perm_b32 v37, v78, v74, s57
  v_perm_b32 v38, v79, v75, s56
  v_perm_b32 v39, v79, v75, s57
  v_dot2_f32_bf16 v40, v32, s55, v40
  v_dot2_f32_bf16 v41, v33, s55, v41
  v_dot2_f32_bf16 v42, v34, s55, v42
  v_dot2_f32_bf16 v43, v35, s55, v43
  v_dot2_f32_bf16 v44, v36, s55, v44
  v_dot2_f32_bf16 v45, v37, s55, v45
  v_dot2_f32_bf16 v46, v38, s55, v46
  v_dot2_f32_bf16 v47, v39, s55, v47
  s_add_u32 s54, s59, 32
  v_readlane_b32 s55, v56, s54
  s_waitcnt vmcnt(2)
  buffer_load_dwordx4 v[92:95], v10, s[32:35], s36 offen
  s_addk_i32 s36, 1152
  s_waitcnt vmcnt(2)
  s_mov_b32 s58, 0
  buffer_load_dwordx4 v[64:67], v11, s[32:35], s58 offen
  v_perm_b32 v32, v84, v80, s56
  v_perm_b32 v33, v84, v80, s57
  v_perm_b32 v34, v85, v81, s56
  v_perm_b32 v35, v85, v81, s57
  v_perm_b32 v36, v86, v82, s56
  v_perm_b32 v37, v86, v82, s57
  v_perm_b32 v38, v87, v83, s56
  v_perm_b32 v39, v87, v83, s57
  v_dot2_f32_bf16 v40, v32, s55, v40
  v_dot2_f32_bf16 v41, v33, s55, v41
  v_dot2_f32_bf16 v42, v34, s55, v42
  v_dot2_f32_bf16 v43, v35, s55, v43
  v_dot2_f32_bf16 v44, v36, s55, v44
  v_dot2_f32_bf16 v45, v37, s55, v45
  v_dot2_f32_bf16 v46, v38, s55, v46
  v_dot2_f32_bf16 v47, v39, s55, v47
  s_add_u32 s54, s59, 48
  v_readlane_b32 s55, v56, s54
  s_waitcnt vmcnt(2)
  s_mov_b32 s58, 1152
  buffer_load_dwordx4 v[68:71], v11, s[32:35], s58 offen
  s_waitcnt vmcnt(2)
  s_mov_b32 s58, 18432
  buffer_load_dwordx4 v[72:75], v11, s[32:35], s58 offen
  v_perm_b32 v32, v92, v88, s56
  v_perm_b32 v33, v92, v88, s57
  v_perm_b32 v34, v93, v89, s56
  v_perm_b32 v35, v93, v89, s57
  v_perm_b32 v36, v94, v90, s56
  v_perm_b32 v37, v94, v90, s57
  v_perm_b32 v38, v95, v91, s56
  v_perm_b32 v39, v95, v91, s57
  v_dot2_f32_bf16 v40, v32, s55, v40
  v_dot2_f32_bf16 v41, v33, s55, v41
  v_dot2_f32_bf16 v42, v34, s55, v42
  v_dot2_f32_bf16 v43, v35, s55, v43
  v_dot2_f32_bf16 v44, v36, s55, v44
  v_dot2_f32_bf16 v45, v37, s55, v45
  v_dot2_f32_bf16 v46, v38, s55, v46
  v_dot2_f32_bf16 v47, v39, s55, v47
  s_waitcnt vmcnt(2)
  s_mov_b32 s58, 19584
  buffer_load_dwordx4 v[76:79], v11, s[32:35], s58 offen
  s_waitcnt vmcnt(2)
  s_mov_b32 s58, 36864
  buffer_load_dwordx4 v[80:83], v11, s[32:35], s58 offen
  s_waitcnt lgkmcnt(0)
  v_perm_b32 v32, v68, v64, s56
  v_perm_b32 v33, v68, v64, s57
  v_perm_b32 v34, v69, v65, s56
  v_perm_b32 v35, v69, v65, s57
  v_perm_b32 v36, v70, v66, s56
  v_perm_b32 v37, v70, v66, s57
  v_perm_b32 v38, v71, v67, s56
  v_perm_b32 v39, v71, v67, s57
  v_dot2_f32_bf16 v48, v32, v16, v48
  v_dot2_f32_bf16 v49, v33, v16, v49
  v_dot2_f32_bf16 v50, v34, v16, v50
  v_dot2_f32_bf16 v51, v35, v16, v51
  v_dot2_f32_bf16 v52, v36, v16, v52
  v_dot2_f32_bf16 v53, v37, v16, v53
  v_dot2_f32_bf16 v54, v38, v16, v54
  v_dot2_f32_bf16 v55, v39, v16, v55
  s_waitcnt vmcnt(2)
  s_mov_b32 s58, 38016
  buffer_load_dwordx4 v[84:87], v11, s[32:35], s58 offen
  s_waitcnt vmcnt(2)
  s_mov_b32 s58, 55296
  buffer_load_dwordx4 v[88:91], v11, s[32:35], s58 offen
  v_perm_b32 v32, v76, v72, s56
  v_perm_b32 v33, v76, v72, s57
  v_perm_b32 v34, v77, v73, s56
  v_perm_b32 v35, v77, v73, s57
  v_perm_b32 v36, v78, v74, s56
  v_perm_b32 v37, v78, v74, s57
  v_perm_b32 v38, v79, v75, s56
  v_perm_b32 v39, v79, v75, s57
  v_dot2_f32_bf16 v48, v32, v17, v48
  v_dot2_f32_bf16 v49, v33, v17, v49
  v_dot2_f32_bf16 v50, v34, v17, v50
  v_dot2_f32_bf16 v51, v35, v17, v51
  v_dot2_f32_bf16 v52, v36, v17, v52
  v_dot2_f32_bf16 v53, v37, v17, v53
  v_dot2_f32_bf16 v54, v38, v17, v54
  v_dot2_f32_bf16 v55, v39, v17, v55
  s_waitcnt vmcnt(2)
  s_mov_b32 s58, 56448
  buffer_load_dwordx4 v[92:95], v11, s[32:35], s58 offen
  s_waitcnt vmcnt(2)
  v_perm_b32 v32, v84, v80, s56
  v_perm_b32 v33, v84, v80, s57
  v_perm_b32 v34, v85, v81, s56
  v_perm_b32 v35, v85, v81, s57
  v_perm_b32 v36, v86, v82, s56
  v_perm_b32 v37, v86, v82, s57
  v_perm_b32 v38, v87, v83, s56
  v_perm_b32 v39, v87, v83, s57
  v_dot2_f32_bf16 v48, v32, v18, v48
  v_dot2_f32_bf16 v49, v33, v18, v49
  v_dot2_f32_bf16 v50, v34, v18, v50
  v_dot2_f32_bf16 v51, v35, v18, v51
  v_dot2_f32_bf16 v52, v36, v18, v52
  v_dot2_f32_bf16 v53, v37, v18, v53
  v_dot2_f32_bf16 v54, v38, v18, v54
  v_dot2_f32_bf16 v55, v39, v18, v55
  s_waitcnt vmcnt(1)
  s_waitcnt vmcnt(0)
  v_perm_b32 v32, v92, v88, s56
  v_perm_b32 v33, v92, v88, s57
  v_perm_b32 v34, v93, v89, s56
  v_perm_b32 v35, v93, v89, s57
  v_perm_b32 v36, v94, v90, s56
  v_perm_b32 v37, v94, v90, s57
  v_perm_b32 v38, v95, v91, s56
  v_perm_b32 v39, v95, v91, s57
  v_dot2_f32_bf16 v48, v32, v19, v48
  v_dot2_f32_bf16 v49, v33, v19, v49
  v_dot2_f32_bf16 v50, v34, v19, v50
  v_dot2_f32_bf16 v51, v35, v19, v51
  v_dot2_f32_bf16 v52, v36, v19, v52
  v_dot2_f32_bf16 v53, v37, v19, v53
  v_dot2_f32_bf16 v54, v38, v19, v54
  v_dot2_f32_bf16 v55, v39, v19, v55
L_nomlp:
  s_lshl_b32 s50, s39, 7
  s_lshl_b32 s51, s64, 5
  s_add_u32 s50, s50, s51
  s_mul_i32 s50, s50, 1152
  v_lshlrev_b32 v10, 4, v1
  v_add_u32 v10, s50, v10
  v_mul_u32_u24 v11, 2304, v8
  v_lshl_add_u32 v11, v9, 4, v11
  v_add_u32 v11, 1024, v11
  v_add_u32 v11, s50, v11
  s_mov_b32 s32, s12
  s_and_b32 s33, s13, 0xffff
  s_mov_b32 s34, 4718592
  s_mov_b32 s35, 0x20000
  s_mov_b32 s56, 0x05040100
  s_mov_b32 s57, 0x07060302
  s_lshl_b32 s58, s31, 1
  s_add_u32 s36, s58, 0
  s_and_b32 s36, s36, 15
  s_mul_i32 s36, s36, 2304
  buffer_load_dwordx4 v[64:67], v10, s[32:35], s36 offen
  s_add_u32 s36, s58, 0
  s_and_b32 s36, s36, 15
  s_mul_i32 s36, s36, 2304
  s_add_u32 s36, s36, 1152
  buffer_load_dwordx4 v[68:71], v10, s[32:35], s36 offen
  s_add_u32 s36, s58, 1
  s_and_b32 s36, s36, 15
  s_mul_i32 s36, s36, 2304
  buffer_load_dwordx4 v[72:75], v10, s[32:35], s36 offen
  s_waitcnt vmcnt(1)
  v_perm_b32 v208, v68, v64, s56
  v_perm_b32 v68, v68, v64, s57
  v_perm_b32 v209, v69, v65, s56
  v_perm_b32 v69, v69, v65, s57
  v_perm_b32 v210, v70, v66, s56
  v_perm_b32 v70, v70, v66, s57
  v_perm_b32 v211, v71, v67, s56
  v_perm_b32 v71, v71, v67, s57
  s_waitcnt vmcnt(2)
  s_add_u32 s36, s58, 1
  s_and_b32 s36, s36, 15
  s_mul_i32 s36, s36, 2304
  s_add_u32 s36, s36, 1152
  buffer_load_dwordx4 v[76:79], v10, s[32:35], s36 offen
  s_waitcnt vmcnt(2)
  s_add_u32 s36, s58, 2
  s_and_b32 s36, s36, 15
  s_mul_i32 s36, s36, 2304
  buffer_load_dwordx4 v[80:83], v10, s[32:35], s36 offen
  s_waitcnt vmcnt(1)
  v_perm_b32 v64, v76, v72, s56
  v_perm_b32 v76, v76, v72, s57
  v_perm_b32 v65, v77, v73, s56
  v_perm_b32 v77, v77, v73, s57
  v_perm_b32 v66, v78, v74, s56
  v_perm_b32 v78, v78, v74, s57
  v_perm_b32 v67, v79, v75, s56
  v_perm_b32 v79, v79, v75, s57
  s_waitcnt vmcnt(2)
  s_add_u32 s36, s58, 2
  s_and_b32 s36, s36, 15
  s_mul_i32 s36, s36, 2304
  s_add_u32 s36, s36, 1152
  buffer_load_dwordx4 v[84:87], v10, s[32:35], s36 offen
  s_waitcnt vmcnt(2)
  s_add_u32 s36, s58, 3
  s_and_b32 s36, s36, 15
  s_mul_i32 s36, s36, 2304
  buffer_load_dwordx4 v[88:91], v10, s[32:35], s36 offen
  s_waitcnt vmcnt(1)
  v_perm_b32 v72, v84, v80, s56
  v_perm_b32 v84, v84, v80, s57
  v_perm_b32 v73, v85, v81, s56
  v_perm_b32 v85, v85, v81, s57
  v_perm_b32 v74, v86, v82, s56
  v_perm_b32 v86, v86, v82, s57
  v_perm_b32 v75, v87, v83, s56
  v_perm_b32 v87, v87, v83, s57
  s_waitcnt vmcnt(2)
  s_add_u32 s36, s58, 3
  s_and_b32 s36, s36, 15
  s_mul_i32 s36, s36, 2304
  s_add_u32 s36, s36, 1152
  buffer_load_dwordx4 v[92:95], v10, s[32:35], s36 offen
  s_waitcnt vmcnt(2)
  s_add_u32 s36, s58, 4
  s_and_b32 s36, s36, 15
  s_mul_i32 s36, s36, 2304
  buffer_load_dwordx4 v[96:99], v10, s[32:35], s36 offen
  s_waitcnt vmcnt(1)
  v_perm_b32 v80, v92, v88, s56
  v_perm_b32 v92, v92, v88, s57
  v_perm_b32 v81, v93, v89, s56
  v_perm_b32 v93, v93, v89, s57
  v_perm_b32 v82, v94, v90, s56
  v_perm_b32 v94, v94, v90, s57
  v_perm_b32 v83, v95, v91, s56
  v_perm_b32 v95, v95, v91, s57
  s_waitcnt vmcnt(2)
  s_add_u32 s36, s58, 4
  s_and_b32 s36, s36, 15
  s_mul_i32 s36, s36, 2304
  s_add_u32 s36, s36, 1152
  buffer_load_dwordx4 v[100:103], v10, s[32:35], s36 offen
  s_waitcnt vmcnt(2)
  s_add_u32 s36, s58, 5
  s_and_b32 s36, s36, 15
  s_mul_i32 s36, s36, 2304
  buffer_load_dwordx4 v[104:107], v10, s[32:35], s36 offen
  s_waitcnt vmcnt(1)
  v_perm_b32 v88, v100, v96, s56
  v_perm_b32 v100, v100, v96, s57
  v_perm_b32 v89, v101, v97, s56
  v_perm_b32 v101, v101, v97, s57
  v_perm_b32 v90, v102, v98, s56
  v_perm_b32 v102, v102, v98, s57
  v_perm_b32 v91, v103, v99, s56
  v_perm_b32 v103, v103, v99, s57
  s_waitcnt vmcnt(2)
  s_add_u32 s36, s58, 5
  s_and_b32 s36, s36, 15
  s_mul_i32 s36, s36, 2304
  s_add_u32 s36, s36, 1152
  buffer_load_dwordx4 v[108:111], v10, s[32:35], s36 offen
  s_waitcnt vmcnt(2)
  s_add_u32 s36, s58, 6
  s_and_b32 s36, s36, 15
  s_mul_i32 s36, s36, 2304
  buffer_load_dwordx4 v[112:115], v10, s[32:35], s36 offen
  s_waitcnt vmcnt(1)
  v_perm_b32 v96, v108, v104, s56
  v_perm_b32 v108, v108, v104, s57
  v_perm_b32 v97, v109, v105, s56
  v_perm_b32 v109, v109, v105, s57
  v_perm_b32 v98, v110, v106, s56
  v_perm_b32 v110, v110, v106, s57
  v_perm_b32 v99, v111, v107, s56
  v_perm_b32 v111, v111, v107, s57
  s_waitcnt vmcnt(2)
  s_add_u32 s36, s58, 6
  s_and_b32 s36, s36, 15
  s_mul_i32 s36, s36, 2304
  s_add_u32 s36, s36, 1152
  buffer_load_dwordx4 v[116:119], v10, s[32:35], s36 offen
  s_waitcnt vmcnt(2)
  s_add_u32 s36, s58, 7
  s_and_b32 s36, s36, 15
  s_mul_i32 s36, s36, 2304
  buffer_load_dwordx4 v[120:123], v10, s[32:35], s36 offen
  s_waitcnt vmcnt(1)
  v_perm_b32 v104, v116, v112, s56
  v_perm_b32 v116, v116, v112, s57
  v_perm_b32 v105, v117, v113, s56
  v_perm_b32 v117, v117, v113, s57
  v_perm_b32 v106, v118, v114, s56
  v_perm_b32 v118, v118, v114, s57
  v_perm_b32 v107, v119, v115, s56
  v_perm_b32 v119, v119, v115, s57
  s_waitcnt vmcnt(2)
  s_add_u32 s36, s58, 7
  s_and_b32 s36, s36, 15
  s_mul_i32 s36, s36, 2304
  s_add_u32 s36, s36, 1152
  buffer_load_dwordx4 v[124:127], v10, s[32:35], s36 offen
  s_waitcnt vmcnt(2)
  s_add_u32 s36, s58, 8
  s_and_b32 s36, s36, 15
  s_mul_i32 s36, s36, 2304
  buffer_load_dwordx4 v[128:131], v10, s[32:35], s36 offen
  s_waitcnt vmcnt(1)
  v_perm_b32 v112, v124, v120, s56
  v_perm_b32 v124, v124, v120, s57
  v_perm_b32 v113, v125, v121, s56
  v_perm_b32 v125, v125, v121, s57
  v_perm_b32 v114, v126, v122, s56
  v_perm_b32 v126, v126, v122, s57
  v_perm_b32 v115, v127, v123, s56
  v_perm_b32 v127, v127, v123, s57
  s_waitcnt vmcnt(2)
  s_add_u32 s36, s58, 8
  s_and_b32 s36, s36, 15
  s_mul_i32 s36, s36, 2304
  s_add_u32 s36, s36, 1152
  buffer_load_dwordx4 v[132:135], v10, s[32:35], s36 offen
  s_waitcnt vmcnt(2)
  s_add_u32 s36, s58, 9
  s_and_b32 s36, s36, 15
  s_mul_i32 s36, s36, 2304
  buffer_load_dwordx4 v[136:139], v10, s[32:35], s36 offen
  s_waitcnt vmcnt(1)
  v_perm_b32 v120, v132, v128, s56
  v_perm_b32 v132, v132, v128, s57
  v_perm_b32 v121, v133, v129, s56
  v_perm_b32 v133, v133, v129, s57
  v_perm_b32 v122, v134, v130, s56
  v_perm_b32 v134, v134, v130, s57
  v_perm_b32 v123, v135, v131, s56
  v_perm_b32 v135, v135, v131, s57
  s_waitcnt vmcnt(2)
  s_add_u32 s36, s58, 9
  s_and_b32 s36, s36, 15
  s_mul_i32 s36, s36, 2304
  s_add_u32 s36, s36, 1152
  buffer_load_dwordx4 v[140:143], v10, s[32:35], s36 offen
  s_waitcnt vmcnt(2)
  s_add_u32 s36, s58, 10
  s_and_b32 s36, s36, 15
  s_mul_i32 s36, s36, 2304
  buffer_load_dwordx4 v[144:147], v10, s[32:35], s36 offen
  s_waitcnt vmcnt(1)
  v_perm_b32 v128, v140, v136, s56
  v_perm_b32 v140, v140, v136, s57
  v_perm_b32 v129, v141, v137, s56
  v_perm_b32 v141, v141, v137, s57
  v_perm_b32 v130, v142, v138, s56
  v_perm_b32 v142, v142, v138, s57
  v_perm_b32 v131, v143, v139, s56
  v_perm_b32 v143, v143, v139, s57
  s_waitcnt vmcnt(2)
  s_add_u32 s36, s58, 10
  s_and_b32 s36, s36, 15
  s_mul_i32 s36, s36, 2304
  s_add_u32 s36, s36, 1152
  buffer_load_dwordx4 v[148:151], v10, s[32:35], s36 offen
  s_waitcnt vmcnt(2)
  s_add_u32 s36, s58, 11
  s_and_b32 s36, s36, 15
  s_mul_i32 s36, s36, 2304
  buffer_load_dwordx4 v[152:155], v10, s[32:35], s36 offen
  s_waitcnt vmcnt(1)
  v_perm_b32 v136, v148, v144, s56
  v_perm_b32 v148, v148, v144, s57
  v_perm_b32 v137, v149, v145, s56
  v_perm_b32 v149, v149, v145, s57
  v_perm_b32 v138, v150, v146, s56
  v_perm_b32 v150, v150, v146, s57
  v_perm_b32 v139, v151, v147, s56
  v_perm_b32 v151, v151, v147, s57
  s_waitcnt vmcnt(2)
  s_add_u32 s36, s58, 11
  s_and_b32 s36, s36, 15
  s_mul_i32 s36, s36, 2304
  s_add_u32 s36, s36, 1152
  buffer_load_dwordx4 v[156:159], v10, s[32:35], s36 offen
  s_waitcnt vmcnt(2)
  s_add_u32 s36, s58, 12
  s_and_b32 s36, s36, 15
  s_mul_i32 s36, s36, 2304
  buffer_load_dwordx4 v[160:163], v10, s[32:35], s36 offen
  s_waitcnt vmcnt(1)
  v_perm_b32 v144, v156, v152, s56
  v_perm_b32 v156, v156, v152, s57
  v_perm_b32 v145, v157, v153, s56
  v_perm_b32 v157, v157, v153, s57
  v_perm_b32 v146, v158, v154, s56
  v_perm_b32 v158, v158, v154, s57
  v_perm_b32 v147, v159, v155, s56
  v_perm_b32 v159, v159, v155, s57
  s_waitcnt vmcnt(2)
  s_add_u32 s36, s58, 12
  s_and_b32 s36, s36, 15
  s_mul_i32 s36, s36, 2304
  s_add_u32 s36, s36, 1152
  buffer_load_dwordx4 v[164:167], v10, s[32:35], s36 offen
  s_waitcnt vmcnt(2)
  s_add_u32 s36, s58, 13
  s_and_b32 s36, s36, 15
  s_mul_i32 s36, s36, 2304
  buffer_load_dwordx4 v[168:171], v10, s[32:35], s36 offen
  s_waitcnt vmcnt(1)
  v_perm_b32 v152, v164, v160, s56
  v_perm_b32 v164, v164, v160, s57
  v_perm_b32 v153, v165, v161, s56
  v_perm_b32 v165, v165, v161, s57
  v_perm_b32 v154, v166, v162, s56
  v_perm_b32 v166, v166, v162, s57
  v_perm_b32 v155, v167, v163, s56
  v_perm_b32 v167, v167, v163, s57
  s_waitcnt vmcnt(2)
  s_add_u32 s36, s58, 13
  s_and_b32 s36, s36, 15
  s_mul_i32 s36, s36, 2304
  s_add_u32 s36, s36, 1152
  buffer_load_dwordx4 v[172:175], v10, s[32:35], s36 offen
  s_waitcnt vmcnt(2)
  s_add_u32 s36, s58, 14
  s_and_b32 s36, s36, 15
  s_mul_i32 s36, s36, 2304
  buffer_load_dwordx4 v[176:179], v10, s[32:35], s36 offen
  s_waitcnt vmcnt(1)
  v_perm_b32 v160, v172, v168, s56
  v_perm_b32 v172, v172, v168, s57
  v_perm_b32 v161, v173, v169, s56
  v_perm_b32 v173, v173, v169, s57
  v_perm_b32 v162, v174, v170, s56
  v_perm_b32 v174, v174, v170, s57
  v_perm_b32 v163, v175, v171, s56
  v_perm_b32 v175, v175, v171, s57
  s_waitcnt vmcnt(2)
  s_add_u32 s36, s58, 14
  s_and_b32 s36, s36, 15
  s_mul_i32 s36, s36, 2304
  s_add_u32 s36, s36, 1152
  buffer_load_dwordx4 v[180:183], v10, s[32:35], s36 offen
  s_waitcnt vmcnt(2)
  s_add_u32 s36, s58, 15
  s_and_b32 s36, s36, 15
  s_mul_i32 s36, s36, 2304
  buffer_load_dwordx4 v[184:187], v10, s[32:35], s36 offen
  s_waitcnt vmcnt(1)
  v_perm_b32 v168, v180, v176, s56
  v_perm_b32 v180, v180, v176, s57
  v_perm_b32 v169, v181, v177, s56
  v_perm_b32 v181, v181, v177, s57
  v_perm_b32 v170, v182, v178, s56
  v_perm_b32 v182, v182, v178, s57
  v_perm_b32 v171, v183, v179, s56
  v_perm_b32 v183, v183, v179, s57
  s_waitcnt vmcnt(2)
  s_add_u32 s36, s58, 15
  s_and_b32 s36, s36, 15
  s_mul_i32 s36, s36, 2304
  s_add_u32 s36, s36, 1152
  buffer_load_dwordx4 v[188:191], v10, s[32:35], s36 offen
  s_waitcnt vmcnt(2)
  s_mov_b32 s36, 0
  buffer_load_dwordx4 v[192:195], v11, s[32:35], s36 offen
  s_waitcnt vmcnt(1)
  v_perm_b32 v176, v188, v184, s56
  v_perm_b32 v188, v188, v184, s57
  v_perm_b32 v177, v189, v185, s56
  v_perm_b32 v189, v189, v185, s57
  v_perm_b32 v178, v190, v186, s56
  v_perm_b32 v190, v190, v186, s57
  v_perm_b32 v179, v191, v187, s56
  v_perm_b32 v191, v191, v187, s57
  s_waitcnt vmcnt(2)
  s_mov_b32 s36, 1152
  buffer_load_dwordx4 v[196:199], v11, s[32:35], s36 offen
  s_waitcnt vmcnt(2)
  s_mov_b32 s36, 18432
  buffer_load_dwordx4 v[200:203], v11, s[32:35], s36 offen
  s_waitcnt vmcnt(1)
  v_perm_b32 v184, v196, v192, s56
  v_perm_b32 v196, v196, v192, s57
  v_perm_b32 v185, v197, v193, s56
  v_perm_b32 v197, v197, v193, s57
  v_perm_b32 v186, v198, v194, s56
  v_perm_b32 v198, v198, v194, s57
  v_perm_b32 v187, v199, v195, s56
  v_perm_b32 v199, v199, v195, s57
  s_waitcnt vmcnt(2)
  s_mov_b32 s36, 19584
  buffer_load_dwordx4 v[204:207], v11, s[32:35], s36 offen
  s_waitcnt vmcnt(0)
  v_perm_b32 v192, v204, v200, s56
  v_perm_b32 v204, v204, v200, s57
  v_perm_b32 v193, v205, v201, s56
  v_perm_b32 v205, v205, v201, s57
  v_perm_b32 v194, v206, v202, s56
  v_perm_b32 v206, v206, v202, s57
  v_perm_b32 v195, v207, v203, s56
  v_perm_b32 v207, v207, v203, s57
  v_add_u32 v6, s58, v1
  v_and_b32 v6, 15, v6
  s_lshl_b32 s50, s64, 4
  v_add_u32 v6, s50, v6
  v_lshlrev_b32 v6, 3, v6
  v_mov_b32 v7, 0
  v_subrev_u32 v12, s58, v8
  v_add_u32 v13, 8, v12
  v_and_b32 v12, 15, v12
  v_and_b32 v13, 15, v13
  v_lshlrev_b32 v12, 2, v12
  v_lshlrev_b32 v13, 2, v13
  s_mul_i32 s50, s64, 2304
  v_lshlrev_b32 v14, 5, v1
  v_add_u32 v14, s50, v14
  v_lshlrev_b32 v15, 5, v9
  v_lshl_add_u32 v15, v2, 3, v15
  v_add_u32 v15, s50, v15
  v_add_u32 v5, 0x10000, v6
  s_cmp_lg_u32 s64, 3
  s_cbranch_scc1 L_nochk
  s_lshl_b32 s50, s31, 2
  s_add_u32 s50, s50, 32
  v_mov_b32 v16, s50
  s_mov_b32 s37, 0x40000
L_chk:
  global_load_dword v17, v16, s[26:27] sc1
  s_waitcnt vmcnt(0)
  v_readfirstlane_b32 s50, v17
  s_nop 0
  s_cmp_ge_u32 s50, 18
  s_cbranch_scc1 L_nochk
  s_sub_u32 s37, s37, 1
  s_cbranch_scc0 L_chk
L_nochk:
  s_mov_b32 s37, 0x400000
L_stw:
  ds_read_b32 v16, v7 offset:6724
  s_waitcnt lgkmcnt(0)
  v_readfirstlane_b32 s50, v16
  s_nop 0
  s_cmp_ge_u32 s50, 4
  s_cbranch_scc1 L_stok
  s_sleep 2
  s_sub_u32 s37, s37, 1
  s_cbranch_scc0 L_stw
L_stok:
  ds_read_b128 v[32:35], v7 offset:6656
  ds_read_b128 v[36:39], v7 offset:6672
  s_waitcnt lgkmcnt(0)
  v_max_f32 v24, v32, v34
  v_max3_f32 v24, v24, v36, v38
  v_sub_f32 v32, v32, v24
  v_mul_f32 v32, s63, v32
  v_exp_f32 v32, v32
  v_sub_f32 v34, v34, v24
  v_mul_f32 v34, s63, v34
  v_exp_f32 v34, v34
  v_sub_f32 v36, v36, v24
  v_mul_f32 v36, s63, v36
  v_exp_f32 v36, v36
  v_sub_f32 v38, v38, v24
  v_mul_f32 v38, s63, v38
  v_exp_f32 v38, v38
  s_nop 0
  v_mul_f32 v25, v32, v33
  v_fmac_f32 v25, v34, v35
  v_fmac_f32 v25, v36, v37
  v_fmac_f32 v25, v38, v39
  v_rcp_f32 v28, v25
  s_nop 0
  v_fma_f32 v29, -v25, v28, 1.0
  v_fma_f32 v28, v29, v28, v28
  v_mul_f32 v32, v32, v28
  v_mul_f32 v34, v34, v28
  v_mul_f32 v36, v36, v28
  v_mul_f32 v38, v38, v28
  s_barrier
  ds_read_b64 v[16:17], v6 offset:23552
  ds_read_b64 v[18:19], v6 offset:56320
  ds_read_b64 v[20:21], v5 offset:23552
  ds_read_b64 v[22:23], v5 offset:56320
  s_waitcnt lgkmcnt(2)
  v_mul_f32 v26, v32, v16
  v_mul_f32 v27, v32, v17
  v_fmac_f32 v26, v34, v18
  v_fmac_f32 v27, v34, v19
  s_waitcnt lgkmcnt(0)
  v_fmac_f32 v26, v36, v20
  v_fmac_f32 v27, v36, v21
  v_fmac_f32 v26, v38, v22
  v_fmac_f32 v27, v38, v23
  v_cvt_pk_bf16_f32 v24, v26, v27
  s_nop 1
  ds_bpermute_b32 v16, v12, v24
  ds_bpermute_b32 v17, v13, v24
  v_dot2c_f32_bf16_dpp v40, v24, v208 row_newbcast:0 row_mask:0xf bank_mask:0xf
  v_dot2c_f32_bf16_dpp v41, v24, v68 row_newbcast:0 row_mask:0xf bank_mask:0xf
  v_dot2c_f32_bf16_dpp v42, v24, v209 row_newbcast:0 row_mask:0xf bank_mask:0xf
  v_dot2c_f32_bf16_dpp v43, v24, v69 row_newbcast:0 row_mask:0xf bank_mask:0xf
  v_dot2c_f32_bf16_dpp v44, v24, v210 row_newbcast:0 row_mask:0xf bank_mask:0xf
  v_dot2c_f32_bf16_dpp v45, v24, v70 row_newbcast:0 row_mask:0xf bank_mask:0xf
  v_dot2c_f32_bf16_dpp v46, v24, v211 row_newbcast:0 row_mask:0xf bank_mask:0xf
  v_dot2c_f32_bf16_dpp v47, v24, v71 row_newbcast:0 row_mask:0xf bank_mask:0xf
  v_dot2c_f32_bf16_dpp v40, v24, v64 row_newbcast:1 row_mask:0xf bank_mask:0xf
  v_dot2c_f32_bf16_dpp v41, v24, v76 row_newbcast:1 row_mask:0xf bank_mask:0xf
  v_dot2c_f32_bf16_dpp v42, v24, v65 row_newbcast:1 row_mask:0xf bank_mask:0xf
  v_dot2c_f32_bf16_dpp v43, v24, v77 row_newbcast:1 row_mask:0xf bank_mask:0xf
  v_dot2c_f32_bf16_dpp v44, v24, v66 row_newbcast:1 row_mask:0xf bank_mask:0xf
  v_dot2c_f32_bf16_dpp v45, v24, v78 row_newbcast:1 row_mask:0xf bank_mask:0xf
  v_dot2c_f32_bf16_dpp v46, v24, v67 row_newbcast:1 row_mask:0xf bank_mask:0xf
  v_dot2c_f32_bf16_dpp v47, v24, v79 row_newbcast:1 row_mask:0xf bank_mask:0xf
  v_dot2c_f32_bf16_dpp v40, v24, v72 row_newbcast:2 row_mask:0xf bank_mask:0xf
  v_dot2c_f32_bf16_dpp v41, v24, v84 row_newbcast:2 row_mask:0xf bank_mask:0xf
  v_dot2c_f32_bf16_dpp v42, v24, v73 row_newbcast:2 row_mask:0xf bank_mask:0xf
  v_dot2c_f32_bf16_dpp v43, v24, v85 row_newbcast:2 row_mask:0xf bank_mask:0xf
  v_dot2c_f32_bf16_dpp v44, v24, v74 row_newbcast:2 row_mask:0xf bank_mask:0xf
  v_dot2c_f32_bf16_dpp v45, v24, v86 row_newbcast:2 row_mask:0xf bank_mask:0xf
  v_dot2c_f32_bf16_dpp v46, v24, v75 row_newbcast:2 row_mask:0xf bank_mask:0xf
  v_dot2c_f32_bf16_dpp v47, v24, v87 row_newbcast:2 row_mask:0xf bank_mask:0xf
  v_dot2c_f32_bf16_dpp v40, v24, v80 row_newbcast:3 row_mask:0xf bank_mask:0xf
  v_dot2c_f32_bf16_dpp v41, v24, v92 row_newbcast:3 row_mask:0xf bank_mask:0xf
  v_dot2c_f32_bf16_dpp v42, v24, v81 row_newbcast:3 row_mask:0xf bank_mask:0xf
  v_dot2c_f32_bf16_dpp v43, v24, v93 row_newbcast:3 row_mask:0xf bank_mask:0xf
  v_dot2c_f32_bf16_dpp v44, v24, v82 row_newbcast:3 row_mask:0xf bank_mask:0xf
  v_dot2c_f32_bf16_dpp v45, v24, v94 row_newbcast:3 row_mask:0xf bank_mask:0xf
  v_dot2c_f32_bf16_dpp v46, v24, v83 row_newbcast:3 row_mask:0xf bank_mask:0xf
  v_dot2c_f32_bf16_dpp v47, v24, v95 row_newbcast:3 row_mask:0xf bank_mask:0xf
  v_dot2c_f32_bf16_dpp v40, v24, v88 row_newbcast:4 row_mask:0xf bank_mask:0xf
  v_dot2c_f32_bf16_dpp v41, v24, v100 row_newbcast:4 row_mask:0xf bank_mask:0xf
  v_dot2c_f32_bf16_dpp v42, v24, v89 row_newbcast:4 row_mask:0xf bank_mask:0xf
  v_dot2c_f32_bf16_dpp v43, v24, v101 row_newbcast:4 row_mask:0xf bank_mask:0xf
  v_dot2c_f32_bf16_dpp v44, v24, v90 row_newbcast:4 row_mask:0xf bank_mask:0xf
  v_dot2c_f32_bf16_dpp v45, v24, v102 row_newbcast:4 row_mask:0xf bank_mask:0xf
  v_dot2c_f32_bf16_dpp v46, v24, v91 row_newbcast:4 row_mask:0xf bank_mask:0xf
  v_dot2c_f32_bf16_dpp v47, v24, v103 row_newbcast:4 row_mask:0xf bank_mask:0xf
  v_dot2c_f32_bf16_dpp v40, v24, v96 row_newbcast:5 row_mask:0xf bank_mask:0xf
  v_dot2c_f32_bf16_dpp v41, v24, v108 row_newbcast:5 row_mask:0xf bank_mask:0xf
  v_dot2c_f32_bf16_dpp v42, v24, v97 row_newbcast:5 row_mask:0xf bank_mask:0xf
  v_dot2c_f32_bf16_dpp v43, v24, v109 row_newbcast:5 row_mask:0xf bank_mask:0xf
  v_dot2c_f32_bf16_dpp v44, v24, v98 row_newbcast:5 row_mask:0xf bank_mask:0xf
  v_dot2c_f32_bf16_dpp v45, v24, v110 row_newbcast:5 row_mask:0xf bank_mask:0xf
  v_dot2c_f32_bf16_dpp v46, v24, v99 row_newbcast:5 row_mask:0xf bank_mask:0xf
  v_dot2c_f32_bf16_dpp v47, v24, v111 row_newbcast:5 row_mask:0xf bank_mask:0xf
  s_waitcnt lgkmcnt(0)
  v_dot2c_f32_bf16 v48, v16, v184
  v_dot2c_f32_bf16 v49, v16, v196
  v_dot2c_f32_bf16 v50, v16, v185
  v_dot2c_f32_bf16 v51, v16, v197
  v_dot2c_f32_bf16 v52, v16, v186
  v_dot2c_f32_bf16 v53, v16, v198
  v_dot2c_f32_bf16 v54, v16, v187
  v_dot2c_f32_bf16 v55, v16, v199
  v_dot2c_f32_bf16 v48, v17, v192
  v_dot2c_f32_bf16 v49, v17, v204
  v_dot2c_f32_bf16 v50, v17, v193
  v_dot2c_f32_bf16 v51, v17, v205
  v_dot2c_f32_bf16 v52, v17, v194
  v_dot2c_f32_bf16 v53, v17, v206
  v_dot2c_f32_bf16 v54, v17, v195
  v_dot2c_f32_bf16 v55, v17, v207
  v_dot2c_f32_bf16_dpp v40, v24, v104 row_newbcast:6 row_mask:0xf bank_mask:0xf
  v_dot2c_f32_bf16_dpp v41, v24, v116 row_newbcast:6 row_mask:0xf bank_mask:0xf
  v_dot2c_f32_bf16_dpp v42, v24, v105 row_newbcast:6 row_mask:0xf bank_mask:0xf
  v_dot2c_f32_bf16_dpp v43, v24, v117 row_newbcast:6 row_mask:0xf bank_mask:0xf
  v_dot2c_f32_bf16_dpp v44, v24, v106 row_newbcast:6 row_mask:0xf bank_mask:0xf
  v_dot2c_f32_bf16_dpp v45, v24, v118 row_newbcast:6 row_mask:0xf bank_mask:0xf
  v_dot2c_f32_bf16_dpp v46, v24, v107 row_newbcast:6 row_mask:0xf bank_mask:0xf
  v_dot2c_f32_bf16_dpp v47, v24, v119 row_newbcast:6 row_mask:0xf bank_mask:0xf
  v_permlane32_swap_b32 v48, v52
  v_permlane32_swap_b32 v49, v53
  v_permlane32_swap_b32 v50, v54
  v_permlane32_swap_b32 v51, v55
  v_dot2c_f32_bf16_dpp v40, v24, v112 row_newbcast:7 row_mask:0xf bank_mask:0xf
  v_dot2c_f32_bf16_dpp v41, v24, v124 row_newbcast:7 row_mask:0xf bank_mask:0xf
  v_dot2c_f32_bf16_dpp v42, v24, v113 row_newbcast:7 row_mask:0xf bank_mask:0xf
  v_dot2c_f32_bf16_dpp v43, v24, v125 row_newbcast:7 row_mask:0xf bank_mask:0xf
  v_dot2c_f32_bf16_dpp v44, v24, v114 row_newbcast:7 row_mask:0xf bank_mask:0xf
  v_dot2c_f32_bf16_dpp v45, v24, v126 row_newbcast:7 row_mask:0xf bank_mask:0xf
  v_dot2c_f32_bf16_dpp v46, v24, v115 row_newbcast:7 row_mask:0xf bank_mask:0xf
  v_dot2c_f32_bf16_dpp v47, v24, v127 row_newbcast:7 row_mask:0xf bank_mask:0xf
  v_add_f32 v48, v48, v52
  v_add_f32 v49, v49, v53
  v_add_f32 v50, v50, v54
  v_add_f32 v51, v51, v55
  v_dot2c_f32_bf16_dpp v40, v24, v120 row_newbcast:8 row_mask:0xf bank_mask:0xf
  v_dot2c_f32_bf16_dpp v41, v24, v132 row_newbcast:8 row_mask:0xf bank_mask:0xf
  v_dot2c_f32_bf16_dpp v42, v24, v121 row_newbcast:8 row_mask:0xf bank_mask:0xf
  v_dot2c_f32_bf16_dpp v43, v24, v133 row_newbcast:8 row_mask:0xf bank_mask:0xf
  v_dot2c_f32_bf16_dpp v44, v24, v122 row_newbcast:8 row_mask:0xf bank_mask:0xf
  v_dot2c_f32_bf16_dpp v45, v24, v134 row_newbcast:8 row_mask:0xf bank_mask:0xf
  v_dot2c_f32_bf16_dpp v46, v24, v123 row_newbcast:8 row_mask:0xf bank_mask:0xf
  v_dot2c_f32_bf16_dpp v47, v24, v135 row_newbcast:8 row_mask:0xf bank_mask:0xf
  v_permlane16_swap_b32 v48, v50
  v_permlane16_swap_b32 v49, v51
  v_dot2c_f32_bf16_dpp v40, v24, v128 row_newbcast:9 row_mask:0xf bank_mask:0xf
  v_dot2c_f32_bf16_dpp v41, v24, v140 row_newbcast:9 row_mask:0xf bank_mask:0xf
  v_dot2c_f32_bf16_dpp v42, v24, v129 row_newbcast:9 row_mask:0xf bank_mask:0xf
  v_dot2c_f32_bf16_dpp v43, v24, v141 row_newbcast:9 row_mask:0xf bank_mask:0xf
  v_dot2c_f32_bf16_dpp v44, v24, v130 row_newbcast:9 row_mask:0xf bank_mask:0xf
  v_dot2c_f32_bf16_dpp v45, v24, v142 row_newbcast:9 row_mask:0xf bank_mask:0xf
  v_dot2c_f32_bf16_dpp v46, v24, v131 row_newbcast:9 row_mask:0xf bank_mask:0xf
  v_dot2c_f32_bf16_dpp v47, v24, v143 row_newbcast:9 row_mask:0xf bank_mask:0xf
  v_add_f32 v48, v48, v50
  v_add_f32 v49, v49, v51
  v_dot2c_f32_bf16_dpp v40, v24, v136 row_newbcast:10 row_mask:0xf bank_mask:0xf
  v_dot2c_f32_bf16_dpp v41, v24, v148 row_newbcast:10 row_mask:0xf bank_mask:0xf
  v_dot2c_f32_bf16_dpp v42, v24, v137 row_newbcast:10 row_mask:0xf bank_mask:0xf
  v_dot2c_f32_bf16_dpp v43, v24, v149 row_newbcast:10 row_mask:0xf bank_mask:0xf
  v_dot2c_f32_bf16_dpp v44, v24, v138 row_newbcast:10 row_mask:0xf bank_mask:0xf
  v_dot2c_f32_bf16_dpp v45, v24, v150 row_newbcast:10 row_mask:0xf bank_mask:0xf
  v_dot2c_f32_bf16_dpp v46, v24, v139 row_newbcast:10 row_mask:0xf bank_mask:0xf
  v_dot2c_f32_bf16_dpp v47, v24, v151 row_newbcast:10 row_mask:0xf bank_mask:0xf
  v_add_f32_dpp v48, v48, v48 row_ror:8 row_mask:0xf bank_mask:0xf
  v_add_f32_dpp v49, v49, v49 row_ror:8 row_mask:0xf bank_mask:0xf
  v_dot2c_f32_bf16_dpp v40, v24, v144 row_newbcast:11 row_mask:0xf bank_mask:0xf
  v_dot2c_f32_bf16_dpp v41, v24, v156 row_newbcast:11 row_mask:0xf bank_mask:0xf
  v_dot2c_f32_bf16_dpp v42, v24, v145 row_newbcast:11 row_mask:0xf bank_mask:0xf
  v_dot2c_f32_bf16_dpp v43, v24, v157 row_newbcast:11 row_mask:0xf bank_mask:0xf
  v_dot2c_f32_bf16_dpp v44, v24, v146 row_newbcast:11 row_mask:0xf bank_mask:0xf
  v_dot2c_f32_bf16_dpp v45, v24, v158 row_newbcast:11 row_mask:0xf bank_mask:0xf
  v_dot2c_f32_bf16_dpp v46, v24, v147 row_newbcast:11 row_mask:0xf bank_mask:0xf
  v_dot2c_f32_bf16_dpp v47, v24, v159 row_newbcast:11 row_mask:0xf bank_mask:0xf
  ds_write_b64 v15, v[48:49] offset:26112
  v_dot2c_f32_bf16_dpp v40, v24, v152 row_newbcast:12 row_mask:0xf bank_mask:0xf
  v_dot2c_f32_bf16_dpp v41, v24, v164 row_newbcast:12 row_mask:0xf bank_mask:0xf
  v_dot2c_f32_bf16_dpp v42, v24, v153 row_newbcast:12 row_mask:0xf bank_mask:0xf
  v_dot2c_f32_bf16_dpp v43, v24, v165 row_newbcast:12 row_mask:0xf bank_mask:0xf
  v_dot2c_f32_bf16_dpp v44, v24, v154 row_newbcast:12 row_mask:0xf bank_mask:0xf
  v_dot2c_f32_bf16_dpp v45, v24, v166 row_newbcast:12 row_mask:0xf bank_mask:0xf
  v_dot2c_f32_bf16_dpp v46, v24, v155 row_newbcast:12 row_mask:0xf bank_mask:0xf
  v_dot2c_f32_bf16_dpp v47, v24, v167 row_newbcast:12 row_mask:0xf bank_mask:0xf
  v_dot2c_f32_bf16_dpp v40, v24, v160 row_newbcast:13 row_mask:0xf bank_mask:0xf
  v_dot2c_f32_bf16_dpp v41, v24, v172 row_newbcast:13 row_mask:0xf bank_mask:0xf
  v_dot2c_f32_bf16_dpp v42, v24, v161 row_newbcast:13 row_mask:0xf bank_mask:0xf
  v_dot2c_f32_bf16_dpp v43, v24, v173 row_newbcast:13 row_mask:0xf bank_mask:0xf
  v_dot2c_f32_bf16_dpp v44, v24, v162 row_newbcast:13 row_mask:0xf bank_mask:0xf
  v_dot2c_f32_bf16_dpp v45, v24, v174 row_newbcast:13 row_mask:0xf bank_mask:0xf
  v_dot2c_f32_bf16_dpp v46, v24, v163 row_newbcast:13 row_mask:0xf bank_mask:0xf
  v_dot2c_f32_bf16_dpp v47, v24, v175 row_newbcast:13 row_mask:0xf bank_mask:0xf
  v_dot2c_f32_bf16_dpp v40, v24, v168 row_newbcast:14 row_mask:0xf bank_mask:0xf
  v_dot2c_f32_bf16_dpp v41, v24, v180 row_newbcast:14 row_mask:0xf bank_mask:0xf
  v_dot2c_f32_bf16_dpp v42, v24, v169 row_newbcast:14 row_mask:0xf bank_mask:0xf
  v_dot2c_f32_bf16_dpp v43, v24, v181 row_newbcast:14 row_mask:0xf bank_mask:0xf
  v_dot2c_f32_bf16_dpp v44, v24, v170 row_newbcast:14 row_mask:0xf bank_mask:0xf
  v_dot2c_f32_bf16_dpp v45, v24, v182 row_newbcast:14 row_mask:0xf bank_mask:0xf
  v_dot2c_f32_bf16_dpp v46, v24, v171 row_newbcast:14 row_mask:0xf bank_mask:0xf
  v_dot2c_f32_bf16_dpp v47, v24, v183 row_newbcast:14 row_mask:0xf bank_mask:0xf
  v_dot2c_f32_bf16_dpp v40, v24, v176 row_newbcast:15 row_mask:0xf bank_mask:0xf
  v_dot2c_f32_bf16_dpp v41, v24, v188 row_newbcast:15 row_mask:0xf bank_mask:0xf
  v_dot2c_f32_bf16_dpp v42, v24, v177 row_newbcast:15 row_mask:0xf bank_mask:0xf
  v_dot2c_f32_bf16_dpp v43, v24, v189 row_newbcast:15 row_mask:0xf bank_mask:0xf
  v_dot2c_f32_bf16_dpp v44, v24, v178 row_newbcast:15 row_mask:0xf bank_mask:0xf
  v_dot2c_f32_bf16_dpp v45, v24, v190 row_newbcast:15 row_mask:0xf bank_mask:0xf
  v_dot2c_f32_bf16_dpp v46, v24, v179 row_newbcast:15 row_mask:0xf bank_mask:0xf
  v_dot2c_f32_bf16_dpp v47, v24, v191 row_newbcast:15 row_mask:0xf bank_mask:0xf
  ds_write_b128 v14, v[40:43] offset:24064
  s_nop 1
  ds_write_b128 v14, v[44:47] offset:24080
  s_waitcnt lgkmcnt(0)
  s_barrier
L_end:
  s_endpgm
L_codeend:
.section .rodata,"a"
.p2align 6
.amdhsa_kernel parallel_sum__mha_block_cached__mixer_channel_mlp__decode_kernel
  .amdhsa_next_free_vgpr 256
  .amdhsa_next_free_sgpr 100
  .amdhsa_accum_offset 256
  .amdhsa_group_segment_fixed_size 0
  .amdhsa_kernarg_size 104
  .amdhsa_user_sgpr_count 2
  .amdhsa_user_sgpr_kernarg_segment_ptr 1
  .amdhsa_system_sgpr_workgroup_id_x 1
  .amdhsa_float_denorm_mode_32 3
.end_amdhsa_kernel
```
